```python
import torch

def _softmax(x, axis=-1):
    return torch.softmax(x, dim=axis)

def _gelu(x):
    return torch.nn.functional.gelu(x, approximate='tanh')

def _silu(x):
    return torch.nn.functional.silu(x)

def _sigmoid(x):
    return torch.sigmoid(x)

def _layernorm(x, axis=-1, eps=1e-05):
    m = x.mean(dim=axis, keepdim=True)
    v = x.var(dim=axis, keepdim=True, unbiased=False)
    return (x - m) / torch.sqrt(v + eps)

def _scatter_add(tgt, idx, src, axis=0):
    return tgt.clone().index_add_(axis, idx, src)

def _segment_sum(src, seg, n):
    out = torch.zeros((n,) + src.shape[1:], dtype=src.dtype)
    return out.index_add_(0, seg, src)

def _pad(x, pw):
    flat = tuple((v for pair in reversed(pw) for v in pair))
    return torch.nn.functional.pad(x, flat)
kernel_name = 'adaLN_cond__grouped_kv_mqa__glu_gated_swiglu__prompt'

def setup_inputs():

    _w = lambda a: (lambda t: t.to(torch.bfloat16) if t.is_floating_point() else t)(torch.as_tensor(a))

    def _A_setup():
        B, S, D, H = (1, 2048, 512, 32)
        Dh = D // H
        return {'x': _w((lambda *s: torch.randn(*s, dtype=torch.bfloat16) * 0.05)(B, S, D)), 'wq': _w((lambda *s: torch.randn(*s, dtype=torch.bfloat16) * 0.1)(D, H * Dh)), 'wk': _w((lambda *s: torch.randn(*s, dtype=torch.bfloat16) * 0.1)(D, Dh)), 'wv': _w((lambda *s: torch.randn(*s, dtype=torch.bfloat16) * 0.1)(D, Dh)), 'wo': _w((lambda *s: torch.randn(*s, dtype=torch.bfloat16) * 0.1)(H * Dh, D))}
    _A_in = _A_setup()

    def _B_setup():
        B, S, D, F = (1, 2048, 512, 1792)
        return {'x': _w((lambda *s: torch.randn(*s, dtype=torch.bfloat16) * 0.05)(B, S, D)), 'w1': _w((lambda *s: torch.randn(*s, dtype=torch.bfloat16) * 1.6)(D, F) * (2.0 / D) ** 0.5), 'w3': _w((lambda *s: torch.randn(*s, dtype=torch.bfloat16) * 1.6)(D, F) * (2.0 / D) ** 0.5), 'w2': _w((lambda *s: torch.randn(*s, dtype=torch.bfloat16) * 1.6)(F, D) * (2.0 / F) ** 0.5)}
    _B_in = _B_setup()
    return {'A_x': _A_in['x'], 'A_wq': _A_in['wq'], 'A_wk': _A_in['wk'], 'A_wv': _A_in['wv'], 'A_wo': _A_in['wo'], 'B_x': _B_in['x'], 'B_w1': _B_in['w1'], 'B_w3': _B_in['w3'], 'B_w2': _B_in['w2'], 'c': _w((lambda *s: torch.randn(*s, dtype=torch.bfloat16) * 0.2)(1, 512) * 8.0), 'w_mod': _w((lambda *s: torch.randn(*s, dtype=torch.bfloat16) * 0.2)(512, 6 * 512) * 512 ** (-0.5) * 8.0)}

def reference(A_x, A_wq, A_wk, A_wv, A_wo, B_x, B_w1, B_w3, B_w2, c, w_mod):

    def _A_ref(x, wq, wk, wv, wo):
        B, S, D = x.shape
        H = 32
        Dh = D // H
        q = (lambda x, *d: x.permute(*d))((x @ wq).reshape(B, S, H, Dh), 0, 2, 1, 3)
        k = x @ wk
        v = x @ wv
        scores = torch.einsum('bhqd,bkd->bhqk', q, k) * Dh ** (-0.5)
        p = _softmax(scores, axis=-1)
        o = torch.einsum('bhqk,bkd->bhqd', p, v)
        return (lambda x, *d: x.permute(*d))(o, 0, 2, 1, 3).reshape(B, S, H * Dh) @ wo

    def _B_ref(x, w1, w3, w2):
        gate = torch.einsum('bsd,df->bsf', x, w1)
        up = torch.einsum('bsd,df->bsf', x, w3)
        h = _silu(gate) * up
        out = torch.einsum('bsf,fd->bsd', h, w2)
        return out
    x = A_x
    mod = (_silu(c) @ w_mod).reshape(c.shape[0], 6, 1, -1)
    sa, ca, ga, sb, cb, gb = (mod[:, 0].clone(), mod[:, 1].clone(), mod[:, 2].clone(), mod[:, 3].clone(), mod[:, 4].clone(), mod[:, 5].clone())
    h = _layernorm(x, axis=-1) * (1 + ca) + sa
    x = x + ga * _A_ref(h, A_wq, A_wk, A_wv, A_wo)
    h = _layernorm(x, axis=-1) * (1 + cb) + sb
    x = x + gb * _B_ref(h, B_w1, B_w3, B_w2)
    return x
```

```asm
; @launch grid=(256,1,1) block=(512,1,1) lds=163840
.amdgcn_target "amdgcn-amd-amdhsa--gfx950"
.text
.globl adaLN_cond__grouped_kv_mqa__glu_gated_swiglu__prompt_kernel
.p2align 8
.type adaLN_cond__grouped_kv_mqa__glu_gated_swiglu__prompt_kernel,@function
adaLN_cond__grouped_kv_mqa__glu_gated_swiglu__prompt_kernel:
  s_cmp_ge_u32 s2, 256
  s_cbranch_scc1 adaLN_cond__grouped_kv_mqa__glu_gated_swiglu__prompt_kernel_end
  s_load_dwordx16 s[32:47], s[0:1], 0
  s_load_dwordx8 s[48:55], s[0:1], 64
  s_load_dwordx4 s[56:59], s[0:1], 96
  v_and_b32 v1, 63, v0
  v_lshrrev_b32 v2, 6, v0
  s_nop 0
  v_readfirstlane_b32 s3, v2
  v_lshlrev_b32 v2, 4, v1
  s_and_b32 s16, s2, 7
  s_lshl_b32 s16, s16, 2
  s_lshr_b32 s17, s2, 6
  s_add_u32 s16, s16, s17
  s_bfe_u32 s17, s2, 0x30003
  s_lshr_b32 s20, s3, 2
  s_lshr_b32 s31, s2, 6
  s_lshl_b32 s31, s31, 5
  s_and_b32 s18, s2, 31
  s_add_u32 s31, s31, s18
  s_bitcmp1_b32 s2, 5
  s_cselect_b32 s31, s31, 96
  s_and_b32 s18, s2, 7
  s_lshl_b32 s18, s18, 1
  s_bfe_u32 s19, s2, 0x10003
  s_add_u32 s18, s18, s19
  s_and_b32 s19, s31, 0xf0
  s_add_u32 s18, s18, s19
  s_lshl_b32 s19, s18, 6
  v_lshrrev_b32 v3, 2, v0
  v_and_b32 v4, 3, v0
  v_mul_u32_u24 v5, 6144, v3
  v_lshl_add_u32 v5, v4, 4, v5
  v_lshlrev_b32 v3, 1, v3
  v_lshrrev_b32 v6, 4, v1
  v_and_b32 v7, 15, v1
  v_lshlrev_b32 v8, 10, v6
  v_lshl_add_u32 v9, v7, 4, v8
  v_bfe_u32 v10, v1, 4, 1
  v_lshlrev_b32 v8, 2, v10
  v_and_b32 v11, 7, v1
  v_xor_b32 v8, v8, v11
  v_lshrrev_b32 v11, 3, v1
  v_lshlrev_b32 v11, 10, v11
  v_lshl_add_u32 v8, v8, 4, v11
  s_waitcnt lgkmcnt(0)
  s_mov_b32 s4, s58
  s_mov_b32 s5, s59
  s_mov_b32 s6, 0x2000000
  s_mov_b32 s7, 0x20000
  s_load_dword s42, s[58:59], 360448
  s_cmp_ge_u32 s31, 96
  s_cbranch_scc1 adaLN_cond__grouped_kv_mqa__glu_gated_swiglu__prompt_kernel_nog2
  s_mov_b32 s8, s52
  s_mov_b32 s9, s53
  s_mov_b32 s10, 0x300000
  s_mov_b32 s11, 0x20000
  s_mov_b32 s12, s50
  s_mov_b32 s13, s51
  s_mov_b32 s14, 0x400
  s_mov_b32 s15, 0x20000
  buffer_load_ushort v128, v3, s[12:15], 0 offen offset:0
  buffer_load_ushort v129, v3, s[12:15], 0 offen offset:256
  buffer_load_ushort v130, v3, s[12:15], 0 offen offset:512
  buffer_load_ushort v131, v3, s[12:15], 0 offen offset:768
  buffer_load_dwordx4 v[136:139], v5, s[8:11], s19 offen
  s_add_u32 s19, s19, 786432
  buffer_load_dwordx4 v[140:143], v5, s[8:11], s19 offen
  s_add_u32 s19, s19, 786432
  buffer_load_dwordx4 v[144:147], v5, s[8:11], s19 offen
  s_add_u32 s19, s19, 786432
  buffer_load_dwordx4 v[148:151], v5, s[8:11], s19 offen
  s_waitcnt vmcnt(4)
  v_lshlrev_b32 v128, 16, v128
  v_lshlrev_b32 v129, 16, v129
  v_lshlrev_b32 v130, 16, v130
  v_lshlrev_b32 v131, 16, v131
  v_mul_f32 v132, 0xbfb8aa3b, v128
  v_mul_f32 v133, 0xbfb8aa3b, v129
  v_mul_f32 v134, 0xbfb8aa3b, v130
  v_mul_f32 v135, 0xbfb8aa3b, v131
  v_exp_f32 v132, v132
  v_exp_f32 v133, v133
  v_exp_f32 v134, v134
  v_exp_f32 v135, v135
  v_add_f32 v132, 1.0, v132
  v_add_f32 v133, 1.0, v133
  v_add_f32 v134, 1.0, v134
  v_add_f32 v135, 1.0, v135
  v_rcp_f32 v132, v132
  v_rcp_f32 v133, v133
  v_rcp_f32 v134, v134
  v_rcp_f32 v135, v135
  v_mul_f32 v128, v128, v132
  v_mul_f32 v129, v129, v133
  v_mul_f32 v130, v130, v134
  v_mul_f32 v131, v131, v135
  v_cvt_pk_bf16_f32 v128, v128, v128
  v_cvt_pk_bf16_f32 v129, v129, v129
  v_cvt_pk_bf16_f32 v130, v130, v130
  v_cvt_pk_bf16_f32 v131, v131, v131
  v_lshlrev_b32 v128, 16, v128
  v_lshlrev_b32 v129, 16, v129
  v_lshlrev_b32 v130, 16, v130
  v_lshlrev_b32 v131, 16, v131
  s_waitcnt vmcnt(3)
  v_lshlrev_b32 v132, 16, v136
  v_and_b32 v133, 0xffff0000, v136
  v_mul_f32 v152, v132, v128
  v_mul_f32 v153, v133, v128
  v_lshlrev_b32 v132, 16, v137
  v_and_b32 v133, 0xffff0000, v137
  v_mul_f32 v154, v132, v128
  v_mul_f32 v155, v133, v128
  v_lshlrev_b32 v132, 16, v138
  v_and_b32 v133, 0xffff0000, v138
  v_mul_f32 v156, v132, v128
  v_mul_f32 v157, v133, v128
  v_lshlrev_b32 v132, 16, v139
  v_and_b32 v133, 0xffff0000, v139
  v_mul_f32 v158, v132, v128
  v_mul_f32 v159, v133, v128
  s_waitcnt vmcnt(2)
  v_lshlrev_b32 v132, 16, v140
  v_and_b32 v133, 0xffff0000, v140
  v_fmac_f32 v152, v132, v129
  v_fmac_f32 v153, v133, v129
  v_lshlrev_b32 v132, 16, v141
  v_and_b32 v133, 0xffff0000, v141
  v_fmac_f32 v154, v132, v129
  v_fmac_f32 v155, v133, v129
  v_lshlrev_b32 v132, 16, v142
  v_and_b32 v133, 0xffff0000, v142
  v_fmac_f32 v156, v132, v129
  v_fmac_f32 v157, v133, v129
  v_lshlrev_b32 v132, 16, v143
  v_and_b32 v133, 0xffff0000, v143
  v_fmac_f32 v158, v132, v129
  v_fmac_f32 v159, v133, v129
  s_waitcnt vmcnt(1)
  v_lshlrev_b32 v132, 16, v144
  v_and_b32 v133, 0xffff0000, v144
  v_fmac_f32 v152, v132, v130
  v_fmac_f32 v153, v133, v130
  v_lshlrev_b32 v132, 16, v145
  v_and_b32 v133, 0xffff0000, v145
  v_fmac_f32 v154, v132, v130
  v_fmac_f32 v155, v133, v130
  v_lshlrev_b32 v132, 16, v146
  v_and_b32 v133, 0xffff0000, v146
  v_fmac_f32 v156, v132, v130
  v_fmac_f32 v157, v133, v130
  v_lshlrev_b32 v132, 16, v147
  v_and_b32 v133, 0xffff0000, v147
  v_fmac_f32 v158, v132, v130
  v_fmac_f32 v159, v133, v130
  s_waitcnt vmcnt(0)
  v_lshlrev_b32 v132, 16, v148
  v_and_b32 v133, 0xffff0000, v148
  v_fmac_f32 v152, v132, v131
  v_fmac_f32 v153, v133, v131
  v_lshlrev_b32 v132, 16, v149
  v_and_b32 v133, 0xffff0000, v149
  v_fmac_f32 v154, v132, v131
  v_fmac_f32 v155, v133, v131
  v_lshlrev_b32 v132, 16, v150
  v_and_b32 v133, 0xffff0000, v150
  v_fmac_f32 v156, v132, v131
  v_fmac_f32 v157, v133, v131
  v_lshlrev_b32 v132, 16, v151
  v_and_b32 v133, 0xffff0000, v151
  v_fmac_f32 v158, v132, v131
  v_fmac_f32 v159, v133, v131
  v_add_f32_dpp v152, v152, v152 row_ror:4 row_mask:0xf bank_mask:0xf
  v_add_f32_dpp v153, v153, v153 row_ror:4 row_mask:0xf bank_mask:0xf
  v_add_f32_dpp v154, v154, v154 row_ror:4 row_mask:0xf bank_mask:0xf
  v_add_f32_dpp v155, v155, v155 row_ror:4 row_mask:0xf bank_mask:0xf
  v_add_f32_dpp v156, v156, v156 row_ror:4 row_mask:0xf bank_mask:0xf
  v_add_f32_dpp v157, v157, v157 row_ror:4 row_mask:0xf bank_mask:0xf
  v_add_f32_dpp v158, v158, v158 row_ror:4 row_mask:0xf bank_mask:0xf
  v_add_f32_dpp v159, v159, v159 row_ror:4 row_mask:0xf bank_mask:0xf
  v_add_f32_dpp v152, v152, v152 row_ror:8 row_mask:0xf bank_mask:0xf
  v_add_f32_dpp v153, v153, v153 row_ror:8 row_mask:0xf bank_mask:0xf
  v_add_f32_dpp v154, v154, v154 row_ror:8 row_mask:0xf bank_mask:0xf
  v_add_f32_dpp v155, v155, v155 row_ror:8 row_mask:0xf bank_mask:0xf
  v_add_f32_dpp v156, v156, v156 row_ror:8 row_mask:0xf bank_mask:0xf
  v_add_f32_dpp v157, v157, v157 row_ror:8 row_mask:0xf bank_mask:0xf
  v_add_f32_dpp v158, v158, v158 row_ror:8 row_mask:0xf bank_mask:0xf
  v_add_f32_dpp v159, v159, v159 row_ror:8 row_mask:0xf bank_mask:0xf
  v_lshrrev_b32 v3, 4, v0
  v_lshlrev_b32 v3, 7, v3
  v_lshl_add_u32 v3, v4, 5, v3
  v_add_u32 v3, 149504, v3
  s_mov_b32 exec_lo, 0x000f000f
  s_mov_b32 exec_hi, 0x000f000f
  ds_write_b128 v3, v[152:155]
  ds_write_b128 v3, v[156:159] offset:16
  s_mov_b64 exec, -1
  s_waitcnt lgkmcnt(0)
  s_barrier
  s_cmp_lg_u32 s3, 0
  s_cbranch_scc1 adaLN_cond__grouped_kv_mqa__glu_gated_swiglu__prompt_kernel_nog2
  v_lshlrev_b32 v3, 2, v1
  v_add_u32 v4, 149504, v3
  ds_read_b32 v128, v4 offset:0
  ds_read_b32 v129, v4 offset:256
  ds_read_b32 v130, v4 offset:512
  ds_read_b32 v131, v4 offset:768
  ds_read_b32 v132, v4 offset:1024
  ds_read_b32 v133, v4 offset:1280
  ds_read_b32 v134, v4 offset:1536
  ds_read_b32 v135, v4 offset:1792
  ds_read_b32 v136, v4 offset:2048
  ds_read_b32 v137, v4 offset:2304
  ds_read_b32 v138, v4 offset:2560
  ds_read_b32 v139, v4 offset:2816
  ds_read_b32 v140, v4 offset:3072
  ds_read_b32 v141, v4 offset:3328
  ds_read_b32 v142, v4 offset:3584
  ds_read_b32 v143, v4 offset:3840
  s_waitcnt lgkmcnt(0)
  v_add_f32 v128, v128, v136
  v_add_f32 v129, v129, v137
  v_add_f32 v130, v130, v138
  v_add_f32 v131, v131, v139
  v_add_f32 v132, v132, v140
  v_add_f32 v133, v133, v141
  v_add_f32 v134, v134, v142
  v_add_f32 v135, v135, v143
  v_add_f32 v128, v128, v132
  v_add_f32 v129, v129, v133
  v_add_f32 v130, v130, v134
  v_add_f32 v131, v131, v135
  v_add_f32 v128, v128, v130
  v_add_f32 v129, v129, v131
  v_add_f32 v128, v128, v129
  v_mov_b32 v129, v128
  s_lshr_b32 s19, s18, 4
  s_bitcmp1_b32 0x12, s19
  v_permlane32_swap_b32 v128, v129
  s_cselect_b32 s21, 1.0, 0
  v_add_f32 v128, v128, v129
  v_cvt_pk_bf16_f32 v128, v128, v128
  v_lshlrev_b32 v128, 16, v128
  v_add_f32 v128, s21, v128
  v_cvt_pk_bf16_f32 v129, v128, v128
  v_lshlrev_b32 v128, 16, v129
  s_add_u32 s42, s42, 1
  s_cmp_ge_u32 s31, 32
  s_cbranch_scc1 adaLN_cond__grouped_kv_mqa__glu_gated_swiglu__prompt_kernel_g2
  v_and_b32 v4, 1, v1
  v_cmp_eq_u32 vcc, 0, v4
  v_mov_b32 v131, 0xffff
  v_mov_b32 v132, 0xffff0000
  v_mov_b32_dpp v130, v129 quad_perm:[1,0,3,2] row_mask:0xf bank_mask:0xf
  v_cndmask_b32 v131, v132, v131, vcc
  v_lshrrev_b32 v3, 5, v1
  v_lshl_add_u32 v4, v3, 1, v4
  v_lshlrev_b32 v4, 12, v4
  v_bfe_u32 v3, v1, 1, 4
  v_lshl_add_u32 v4, v3, 3, v4
  v_bfi_b32 v128, v131, v129, v130
  v_mov_b32 v129, s42
  s_lshl_b32 s19, s18, 7
  s_add_u32 s19, s19, 262144
  s_add_u32 s21, s19, 16384
  buffer_store_dwordx2 v[128:129], v4, s[4:7], s19 offen sc1
  buffer_store_dwordx2 v[128:129], v4, s[4:7], s21 offen sc1
  s_branch adaLN_cond__grouped_kv_mqa__glu_gated_swiglu__prompt_kernel_g3
adaLN_cond__grouped_kv_mqa__glu_gated_swiglu__prompt_kernel_g2:
  s_mov_b32 exec_hi, 0
  s_lshl_b32 s19, s18, 7
  v_lshlrev_b32 v4, 1, v1
  buffer_store_dword v128, v3, s[4:7], s19 offen sc1
  s_lshl_b32 s19, s18, 6
  s_add_u32 s19, s19, 12288
  buffer_store_short v129, v4, s[4:7], s19 offen sc1
  s_lshl_b32 s19, s31, 2
  s_add_u32 s19, s19, 368512
  s_waitcnt vmcnt(0)
  s_mov_b64 exec, 1
  v_lshlrev_b32 v128, 9, v1
  v_mov_b32 v129, s42
  buffer_store_dword v129, v128, s[4:7], s19 offen sc1
  s_mov_b64 exec, -1
adaLN_cond__grouped_kv_mqa__glu_gated_swiglu__prompt_kernel_g3:
  s_sub_u32 s42, s42, 1
adaLN_cond__grouped_kv_mqa__glu_gated_swiglu__prompt_kernel_nog2:
  s_mov_b32 s8, s32
  s_mov_b32 s9, s33
  s_mov_b32 s10, 0x200000
  s_mov_b32 s11, 0x20000
  s_mov_b32 s12, s34
  s_mov_b32 s13, s35
  s_mov_b32 s14, 0x80000
  s_mov_b32 s15, 0x20000
  s_lshl_b32 s19, s16, 16
  s_lshl_b32 s21, s3, 13
  s_add_u32 s19, s19, s21
  s_add_u32 s21, s19, 4096
  buffer_load_dwordx4 v[16:19], v9, s[8:11], s19 offen offset:0
  buffer_load_dwordx4 v[20:23], v9, s[8:11], s19 offen offset:256
  buffer_load_dwordx4 v[24:27], v9, s[8:11], s19 offen offset:512
  buffer_load_dwordx4 v[28:31], v9, s[8:11], s19 offen offset:768
  buffer_load_dwordx4 v[32:35], v9, s[8:11], s21 offen offset:0
  buffer_load_dwordx4 v[36:39], v9, s[8:11], s21 offen offset:256
  buffer_load_dwordx4 v[40:43], v9, s[8:11], s21 offen offset:512
  buffer_load_dwordx4 v[44:47], v9, s[8:11], s21 offen offset:768
  s_barrier
  s_bitcmp1_b32 s17, 0
  s_cselect_b32 s8, s38, s36
  s_cselect_b32 s9, s39, s37
  s_mov_b32 s10, 16384
  s_lshl_b32 s19, s3, 11
  s_add_u32 m0, s19, 133120
  s_nop 0
  buffer_load_dwordx4 v2, s[8:11], s19 offen lds
  buffer_load_dwordx4 v2, s[8:11], s19 offen offset:1024 lds
  s_lshl_b32 s19, s3, 16
  s_lshl_b32 s21, s17, 7
  s_add_u32 s19, s19, s21
  s_lshl_b32 s21, s3, 13
  s_add_u32 m0, s21, 0
  s_nop 0
  buffer_load_dwordx4 v8, s[12:15], s19 offen lds
  s_add_u32 s19, s19, 8192
  s_add_u32 m0, s21, 1024
  s_nop 0
  buffer_load_dwordx4 v8, s[12:15], s19 offen lds
  s_add_u32 s19, s19, 8192
  s_add_u32 m0, s21, 2048
  s_nop 0
  buffer_load_dwordx4 v8, s[12:15], s19 offen lds
  s_add_u32 s19, s19, 8192
  s_add_u32 m0, s21, 3072
  s_nop 0
  buffer_load_dwordx4 v8, s[12:15], s19 offen lds
  s_add_u32 s19, s19, 8192
  s_add_u32 m0, s21, 4096
  s_nop 0
  buffer_load_dwordx4 v8, s[12:15], s19 offen lds
  s_add_u32 s19, s19, 8192
  s_add_u32 m0, s21, 5120
  s_nop 0
  buffer_load_dwordx4 v8, s[12:15], s19 offen lds
  s_add_u32 s19, s19, 8192
  s_add_u32 m0, s21, 6144
  s_nop 0
  buffer_load_dwordx4 v8, s[12:15], s19 offen lds
  s_add_u32 s19, s19, 8192
  s_add_u32 m0, s21, 7168
  s_nop 0
  buffer_load_dwordx4 v8, s[12:15], s19 offen lds
  s_add_u32 s19, s19, 8192
  s_mov_b32 s21, 0x3f803f80
  v_mov_b32 v12, 0
  v_mov_b32 v13, 0
  v_mov_b32 v14, 0
  v_mov_b32 v15, 0
  s_waitcnt vmcnt(10)
  v_dot2_f32_bf16 v12, v16, s21, v12
  v_dot2_f32_bf16 v13, v16, v16, v13
  v_dot2_f32_bf16 v14, v32, s21, v14
  v_dot2_f32_bf16 v15, v32, v32, v15
  v_dot2_f32_bf16 v12, v17, s21, v12
  v_dot2_f32_bf16 v13, v17, v17, v13
  v_dot2_f32_bf16 v14, v33, s21, v14
  v_dot2_f32_bf16 v15, v33, v33, v15
  v_dot2_f32_bf16 v12, v18, s21, v12
  v_dot2_f32_bf16 v13, v18, v18, v13
  v_dot2_f32_bf16 v14, v34, s21, v14
  v_dot2_f32_bf16 v15, v34, v34, v15
  v_dot2_f32_bf16 v12, v19, s21, v12
  v_dot2_f32_bf16 v13, v19, v19, v13
  v_dot2_f32_bf16 v14, v35, s21, v14
  v_dot2_f32_bf16 v15, v35, v35, v15
  v_dot2_f32_bf16 v12, v20, s21, v12
  v_dot2_f32_bf16 v13, v20, v20, v13
  v_dot2_f32_bf16 v14, v36, s21, v14
  v_dot2_f32_bf16 v15, v36, v36, v15
  v_dot2_f32_bf16 v12, v21, s21, v12
  v_dot2_f32_bf16 v13, v21, v21, v13
  v_dot2_f32_bf16 v14, v37, s21, v14
  v_dot2_f32_bf16 v15, v37, v37, v15
  v_dot2_f32_bf16 v12, v22, s21, v12
  v_dot2_f32_bf16 v13, v22, v22, v13
  v_dot2_f32_bf16 v14, v38, s21, v14
  v_dot2_f32_bf16 v15, v38, v38, v15
  v_dot2_f32_bf16 v12, v23, s21, v12
  v_dot2_f32_bf16 v13, v23, v23, v13
  v_dot2_f32_bf16 v14, v39, s21, v14
  v_dot2_f32_bf16 v15, v39, v39, v15
  v_dot2_f32_bf16 v12, v24, s21, v12
  v_dot2_f32_bf16 v13, v24, v24, v13
  v_dot2_f32_bf16 v14, v40, s21, v14
  v_dot2_f32_bf16 v15, v40, v40, v15
  v_dot2_f32_bf16 v12, v25, s21, v12
  v_dot2_f32_bf16 v13, v25, v25, v13
  v_dot2_f32_bf16 v14, v41, s21, v14
  v_dot2_f32_bf16 v15, v41, v41, v15
  v_dot2_f32_bf16 v12, v26, s21, v12
  v_dot2_f32_bf16 v13, v26, v26, v13
  v_dot2_f32_bf16 v14, v42, s21, v14
  v_dot2_f32_bf16 v15, v42, v42, v15
  v_dot2_f32_bf16 v12, v27, s21, v12
  v_dot2_f32_bf16 v13, v27, v27, v13
  v_dot2_f32_bf16 v14, v43, s21, v14
  v_dot2_f32_bf16 v15, v43, v43, v15
  v_dot2_f32_bf16 v12, v28, s21, v12
  v_dot2_f32_bf16 v13, v28, v28, v13
  v_dot2_f32_bf16 v14, v44, s21, v14
  v_dot2_f32_bf16 v15, v44, v44, v15
  v_dot2_f32_bf16 v12, v29, s21, v12
  v_dot2_f32_bf16 v13, v29, v29, v13
  v_dot2_f32_bf16 v14, v45, s21, v14
  v_dot2_f32_bf16 v15, v45, v45, v15
  v_dot2_f32_bf16 v12, v30, s21, v12
  v_dot2_f32_bf16 v13, v30, v30, v13
  v_dot2_f32_bf16 v14, v46, s21, v14
  v_dot2_f32_bf16 v15, v46, v46, v15
  v_dot2_f32_bf16 v12, v31, s21, v12
  v_dot2_f32_bf16 v13, v31, v31, v13
  v_dot2_f32_bf16 v14, v47, s21, v14
  v_dot2_f32_bf16 v15, v47, v47, v15
  s_nop 2
  v_add_f32_dpp v12, v12, v12 row_ror:8 row_mask:0xf bank_mask:0xf
  v_add_f32_dpp v13, v13, v13 row_ror:8 row_mask:0xf bank_mask:0xf
  v_add_f32_dpp v14, v14, v14 row_ror:8 row_mask:0xf bank_mask:0xf
  v_add_f32_dpp v15, v15, v15 row_ror:8 row_mask:0xf bank_mask:0xf
  v_add_f32_dpp v12, v12, v12 row_ror:4 row_mask:0xf bank_mask:0xf
  v_add_f32_dpp v13, v13, v13 row_ror:4 row_mask:0xf bank_mask:0xf
  v_add_f32_dpp v14, v14, v14 row_ror:4 row_mask:0xf bank_mask:0xf
  v_add_f32_dpp v15, v15, v15 row_ror:4 row_mask:0xf bank_mask:0xf
  v_add_f32_dpp v12, v12, v12 row_ror:2 row_mask:0xf bank_mask:0xf
  v_add_f32_dpp v13, v13, v13 row_ror:2 row_mask:0xf bank_mask:0xf
  v_add_f32_dpp v14, v14, v14 row_ror:2 row_mask:0xf bank_mask:0xf
  v_add_f32_dpp v15, v15, v15 row_ror:2 row_mask:0xf bank_mask:0xf
  v_add_f32_dpp v12, v12, v12 row_ror:1 row_mask:0xf bank_mask:0xf
  v_add_f32_dpp v13, v13, v13 row_ror:1 row_mask:0xf bank_mask:0xf
  v_add_f32_dpp v14, v14, v14 row_ror:1 row_mask:0xf bank_mask:0xf
  v_add_f32_dpp v15, v15, v15 row_ror:1 row_mask:0xf bank_mask:0xf
  v_mul_f32 v12, 0x3b000000, v12
  v_mul_f32 v13, 0x3b000000, v13
  v_fma_f32 v13, -v12, v12, v13
  v_max_f32 v13, 0, v13
  v_add_f32 v13, 0x3727c5ac, v13
  v_rsq_f32 v13, v13
  s_nop 0
  v_mul_f32 v12, v12, v13
  v_lshlrev_b32 v48, 16, v16
  v_and_b32 v49, 0xffff0000, v16
  v_lshlrev_b32 v50, 16, v17
  v_and_b32 v51, 0xffff0000, v17
  v_lshlrev_b32 v52, 16, v18
  v_and_b32 v53, 0xffff0000, v18
  v_lshlrev_b32 v54, 16, v19
  v_and_b32 v55, 0xffff0000, v19
  v_lshlrev_b32 v56, 16, v20
  v_and_b32 v57, 0xffff0000, v20
  v_lshlrev_b32 v58, 16, v21
  v_and_b32 v59, 0xffff0000, v21
  v_lshlrev_b32 v60, 16, v22
  v_and_b32 v61, 0xffff0000, v22
  v_lshlrev_b32 v62, 16, v23
  v_and_b32 v63, 0xffff0000, v23
  v_lshlrev_b32 v64, 16, v24
  v_and_b32 v65, 0xffff0000, v24
  v_lshlrev_b32 v66, 16, v25
  v_and_b32 v67, 0xffff0000, v25
  v_lshlrev_b32 v68, 16, v26
  v_and_b32 v69, 0xffff0000, v26
  v_lshlrev_b32 v70, 16, v27
  v_and_b32 v71, 0xffff0000, v27
  v_lshlrev_b32 v72, 16, v28
  v_and_b32 v73, 0xffff0000, v28
  v_lshlrev_b32 v74, 16, v29
  v_and_b32 v75, 0xffff0000, v29
  v_lshlrev_b32 v76, 16, v30
  v_and_b32 v77, 0xffff0000, v30
  v_lshlrev_b32 v78, 16, v31
  v_and_b32 v79, 0xffff0000, v31
  v_pk_fma_f32 v[48:49], v[48:49], v[12:13], v[12:13] op_sel:[0,1,0] op_sel_hi:[1,1,0] neg_lo:[0,0,1] neg_hi:[0,0,1]
  v_pk_fma_f32 v[50:51], v[50:51], v[12:13], v[12:13] op_sel:[0,1,0] op_sel_hi:[1,1,0] neg_lo:[0,0,1] neg_hi:[0,0,1]
  v_pk_fma_f32 v[52:53], v[52:53], v[12:13], v[12:13] op_sel:[0,1,0] op_sel_hi:[1,1,0] neg_lo:[0,0,1] neg_hi:[0,0,1]
  v_pk_fma_f32 v[54:55], v[54:55], v[12:13], v[12:13] op_sel:[0,1,0] op_sel_hi:[1,1,0] neg_lo:[0,0,1] neg_hi:[0,0,1]
  v_pk_fma_f32 v[56:57], v[56:57], v[12:13], v[12:13] op_sel:[0,1,0] op_sel_hi:[1,1,0] neg_lo:[0,0,1] neg_hi:[0,0,1]
  v_pk_fma_f32 v[58:59], v[58:59], v[12:13], v[12:13] op_sel:[0,1,0] op_sel_hi:[1,1,0] neg_lo:[0,0,1] neg_hi:[0,0,1]
  v_pk_fma_f32 v[60:61], v[60:61], v[12:13], v[12:13] op_sel:[0,1,0] op_sel_hi:[1,1,0] neg_lo:[0,0,1] neg_hi:[0,0,1]
  v_pk_fma_f32 v[62:63], v[62:63], v[12:13], v[12:13] op_sel:[0,1,0] op_sel_hi:[1,1,0] neg_lo:[0,0,1] neg_hi:[0,0,1]
  v_pk_fma_f32 v[64:65], v[64:65], v[12:13], v[12:13] op_sel:[0,1,0] op_sel_hi:[1,1,0] neg_lo:[0,0,1] neg_hi:[0,0,1]
  v_pk_fma_f32 v[66:67], v[66:67], v[12:13], v[12:13] op_sel:[0,1,0] op_sel_hi:[1,1,0] neg_lo:[0,0,1] neg_hi:[0,0,1]
  v_pk_fma_f32 v[68:69], v[68:69], v[12:13], v[12:13] op_sel:[0,1,0] op_sel_hi:[1,1,0] neg_lo:[0,0,1] neg_hi:[0,0,1]
  v_pk_fma_f32 v[70:71], v[70:71], v[12:13], v[12:13] op_sel:[0,1,0] op_sel_hi:[1,1,0] neg_lo:[0,0,1] neg_hi:[0,0,1]
  v_pk_fma_f32 v[72:73], v[72:73], v[12:13], v[12:13] op_sel:[0,1,0] op_sel_hi:[1,1,0] neg_lo:[0,0,1] neg_hi:[0,0,1]
  v_pk_fma_f32 v[74:75], v[74:75], v[12:13], v[12:13] op_sel:[0,1,0] op_sel_hi:[1,1,0] neg_lo:[0,0,1] neg_hi:[0,0,1]
  v_pk_fma_f32 v[76:77], v[76:77], v[12:13], v[12:13] op_sel:[0,1,0] op_sel_hi:[1,1,0] neg_lo:[0,0,1] neg_hi:[0,0,1]
  v_pk_fma_f32 v[78:79], v[78:79], v[12:13], v[12:13] op_sel:[0,1,0] op_sel_hi:[1,1,0] neg_lo:[0,0,1] neg_hi:[0,0,1]
  v_mul_f32 v14, 0x3b000000, v14
  v_mul_f32 v15, 0x3b000000, v15
  v_fma_f32 v15, -v14, v14, v15
  v_max_f32 v15, 0, v15
  v_add_f32 v15, 0x3727c5ac, v15
  v_rsq_f32 v15, v15
  s_nop 0
  v_mul_f32 v14, v14, v15
  v_lshlrev_b32 v80, 16, v32
  v_and_b32 v81, 0xffff0000, v32
  v_lshlrev_b32 v82, 16, v33
  v_and_b32 v83, 0xffff0000, v33
  v_lshlrev_b32 v84, 16, v34
  v_and_b32 v85, 0xffff0000, v34
  v_lshlrev_b32 v86, 16, v35
  v_and_b32 v87, 0xffff0000, v35
  v_lshlrev_b32 v88, 16, v36
  v_and_b32 v89, 0xffff0000, v36
  v_lshlrev_b32 v90, 16, v37
  v_and_b32 v91, 0xffff0000, v37
  v_lshlrev_b32 v92, 16, v38
  v_and_b32 v93, 0xffff0000, v38
  v_lshlrev_b32 v94, 16, v39
  v_and_b32 v95, 0xffff0000, v39
  v_lshlrev_b32 v96, 16, v40
  v_and_b32 v97, 0xffff0000, v40
  v_lshlrev_b32 v98, 16, v41
  v_and_b32 v99, 0xffff0000, v41
  v_lshlrev_b32 v100, 16, v42
  v_and_b32 v101, 0xffff0000, v42
  v_lshlrev_b32 v102, 16, v43
  v_and_b32 v103, 0xffff0000, v43
  v_lshlrev_b32 v104, 16, v44
  v_and_b32 v105, 0xffff0000, v44
  v_lshlrev_b32 v106, 16, v45
  v_and_b32 v107, 0xffff0000, v45
  v_lshlrev_b32 v108, 16, v46
  v_and_b32 v109, 0xffff0000, v46
  v_lshlrev_b32 v110, 16, v47
  v_and_b32 v111, 0xffff0000, v47
  v_pk_fma_f32 v[80:81], v[80:81], v[14:15], v[14:15] op_sel:[0,1,0] op_sel_hi:[1,1,0] neg_lo:[0,0,1] neg_hi:[0,0,1]
  v_pk_fma_f32 v[82:83], v[82:83], v[14:15], v[14:15] op_sel:[0,1,0] op_sel_hi:[1,1,0] neg_lo:[0,0,1] neg_hi:[0,0,1]
  v_pk_fma_f32 v[84:85], v[84:85], v[14:15], v[14:15] op_sel:[0,1,0] op_sel_hi:[1,1,0] neg_lo:[0,0,1] neg_hi:[0,0,1]
  v_pk_fma_f32 v[86:87], v[86:87], v[14:15], v[14:15] op_sel:[0,1,0] op_sel_hi:[1,1,0] neg_lo:[0,0,1] neg_hi:[0,0,1]
  v_pk_fma_f32 v[88:89], v[88:89], v[14:15], v[14:15] op_sel:[0,1,0] op_sel_hi:[1,1,0] neg_lo:[0,0,1] neg_hi:[0,0,1]
  v_pk_fma_f32 v[90:91], v[90:91], v[14:15], v[14:15] op_sel:[0,1,0] op_sel_hi:[1,1,0] neg_lo:[0,0,1] neg_hi:[0,0,1]
  v_pk_fma_f32 v[92:93], v[92:93], v[14:15], v[14:15] op_sel:[0,1,0] op_sel_hi:[1,1,0] neg_lo:[0,0,1] neg_hi:[0,0,1]
  v_pk_fma_f32 v[94:95], v[94:95], v[14:15], v[14:15] op_sel:[0,1,0] op_sel_hi:[1,1,0] neg_lo:[0,0,1] neg_hi:[0,0,1]
  v_pk_fma_f32 v[96:97], v[96:97], v[14:15], v[14:15] op_sel:[0,1,0] op_sel_hi:[1,1,0] neg_lo:[0,0,1] neg_hi:[0,0,1]
  v_pk_fma_f32 v[98:99], v[98:99], v[14:15], v[14:15] op_sel:[0,1,0] op_sel_hi:[1,1,0] neg_lo:[0,0,1] neg_hi:[0,0,1]
  v_pk_fma_f32 v[100:101], v[100:101], v[14:15], v[14:15] op_sel:[0,1,0] op_sel_hi:[1,1,0] neg_lo:[0,0,1] neg_hi:[0,0,1]
  v_pk_fma_f32 v[102:103], v[102:103], v[14:15], v[14:15] op_sel:[0,1,0] op_sel_hi:[1,1,0] neg_lo:[0,0,1] neg_hi:[0,0,1]
  v_pk_fma_f32 v[104:105], v[104:105], v[14:15], v[14:15] op_sel:[0,1,0] op_sel_hi:[1,1,0] neg_lo:[0,0,1] neg_hi:[0,0,1]
  v_pk_fma_f32 v[106:107], v[106:107], v[14:15], v[14:15] op_sel:[0,1,0] op_sel_hi:[1,1,0] neg_lo:[0,0,1] neg_hi:[0,0,1]
  v_pk_fma_f32 v[108:109], v[108:109], v[14:15], v[14:15] op_sel:[0,1,0] op_sel_hi:[1,1,0] neg_lo:[0,0,1] neg_hi:[0,0,1]
  v_pk_fma_f32 v[110:111], v[110:111], v[14:15], v[14:15] op_sel:[0,1,0] op_sel_hi:[1,1,0] neg_lo:[0,0,1] neg_hi:[0,0,1]
  v_lshrrev_b32 v3, 5, v1
  v_bfe_u32 v4, v1, 2, 2
  v_and_b32 v5, 3, v1
  s_bfe_u32 s19, s3, 0x10001
  v_lshl_add_u32 v11, v3, 3, v4
  v_lshlrev_b32 v12, 7, v11
  v_lshrrev_b32 v4, 1, v4
  v_xor_b32 v4, s19, v4
  v_lshl_add_u32 v12, v4, 6, v12
  v_lshl_add_u32 v12, v10, 5, v12
  v_lshl_add_u32 v12, v5, 3, v12
  s_lshl_b32 s21, s20, 15
  v_add_u32 v12, s21, v12
  v_lshlrev_b32 v11, 5, v11
  v_lshl_add_u32 v11, v5, 3, v11
  s_lshl_b32 s21, s3, 11
  s_add_u32 s21, s21, 133120
  v_add_u32 v11, s21, v11
  v_add_u32 v13, s21, v2
  s_waitcnt vmcnt(8)
  ds_read_b64_tr_b16 v[112:113], v11 offset:0
  ds_read_b64_tr_b16 v[114:115], v11 offset:128
  ds_read_b64_tr_b16 v[116:117], v11 offset:512
  ds_read_b64_tr_b16 v[118:119], v11 offset:640
  ds_read_b64_tr_b16 v[120:121], v11 offset:1024
  ds_read_b64_tr_b16 v[122:123], v11 offset:1152
  ds_read_b64_tr_b16 v[124:125], v11 offset:1536
  ds_read_b64_tr_b16 v[126:127], v11 offset:1664
  v_lshlrev_b32 v4, 5, v7
  v_mul_u32_u24 v5, 528, v7
  v_lshl_add_u32 v5, v6, 4, v5
  s_and_b32 s21, s3, 3
  s_lshl_b32 s21, s21, 7
  s_mul_i32 s29, s20, 33792
  s_add_u32 s21, s21, s29
  s_add_u32 s21, s21, 65536
  v_add_u32 v5, s21, v5
  s_waitcnt lgkmcnt(0)
  s_add_u32 s42, s42, 1
  v_lshlrev_b32 v14, 3, v0
  s_and_b32 s21, s2, 7
  s_lshl_b32 s21, s21, 12
  s_add_u32 s21, s21, 262144
  v_add_u32 v4, 153600, v4
  s_waitcnt vmcnt(0)
  s_barrier
  ds_read_b64_tr_b16 v[192:193], v12 offset:0
  ds_read_b64_tr_b16 v[194:195], v12 offset:512
  ds_read_b64_tr_b16 v[196:197], v12 offset:2048
  ds_read_b64_tr_b16 v[198:199], v12 offset:2560
  ds_read_b64_tr_b16 v[200:201], v12 offset:4096
  ds_read_b64_tr_b16 v[202:203], v12 offset:4608
  ds_read_b64_tr_b16 v[204:205], v12 offset:6144
  ds_read_b64_tr_b16 v[206:207], v12 offset:6656
  ds_read_b64_tr_b16 v[208:209], v12 offset:8192
  ds_read_b64_tr_b16 v[210:211], v12 offset:8704
  ds_read_b64_tr_b16 v[212:213], v12 offset:10240
  ds_read_b64_tr_b16 v[214:215], v12 offset:10752
  ds_read_b64_tr_b16 v[216:217], v12 offset:12288
  ds_read_b64_tr_b16 v[218:219], v12 offset:12800
  ds_read_b64_tr_b16 v[220:221], v12 offset:14336
  ds_read_b64_tr_b16 v[222:223], v12 offset:14848
  ds_read_b64_tr_b16 v[224:225], v12 offset:16384
  ds_read_b64_tr_b16 v[226:227], v12 offset:16896
  ds_read_b64_tr_b16 v[228:229], v12 offset:18432
  ds_read_b64_tr_b16 v[230:231], v12 offset:18944
  ds_read_b64_tr_b16 v[232:233], v12 offset:20480
  ds_read_b64_tr_b16 v[234:235], v12 offset:20992
  ds_read_b64_tr_b16 v[236:237], v12 offset:22528
  ds_read_b64_tr_b16 v[238:239], v12 offset:23040
  ds_read_b64_tr_b16 v[240:241], v12 offset:24576
  ds_read_b64_tr_b16 v[242:243], v12 offset:25088
  ds_read_b64_tr_b16 v[244:245], v12 offset:26624
  ds_read_b64_tr_b16 v[246:247], v12 offset:27136
  ds_read_b64_tr_b16 v[248:249], v12 offset:28672
  ds_read_b64_tr_b16 v[250:251], v12 offset:29184
  ds_read_b64_tr_b16 v[252:253], v12 offset:30720
  ds_read_b64_tr_b16 v[254:255], v12 offset:31232
  s_mov_b32 s30, 0
adaLN_cond__grouped_kv_mqa__glu_gated_swiglu__prompt_kernel_poll1:
  buffer_load_dwordx2 v[128:129], v14, s[4:7], s21 offen offset:0 sc1
  s_add_u32 s30, s30, 1
  s_waitcnt vmcnt(0)
  v_cmp_ne_u32 vcc, s42, v129
  s_nop 1
  s_cbranch_vccz adaLN_cond__grouped_kv_mqa__glu_gated_swiglu__prompt_kernel_poll1d
  s_sleep 4
  s_cmp_lt_u32 s30, 0x20000
  s_cbranch_scc1 adaLN_cond__grouped_kv_mqa__glu_gated_swiglu__prompt_kernel_poll1
adaLN_cond__grouped_kv_mqa__glu_gated_swiglu__prompt_kernel_poll1d:
  v_add_u32 v14, 153600, v14
  v_and_b32 v129, 0xffff0000, v128
  v_lshlrev_b32 v128, 16, v128
  ds_write_b64 v14, v[128:129]
  s_waitcnt lgkmcnt(0)
  s_barrier
  ds_read_b128 v[128:131], v4 offset:0
  ds_read_b128 v[136:139], v4 offset:2048
  ds_read_b128 v[132:135], v4 offset:16
  ds_read_b128 v[140:143], v4 offset:2064
  ds_read_b128 v[144:147], v4 offset:512
  ds_read_b128 v[152:155], v4 offset:2560
  ds_read_b128 v[148:151], v4 offset:528
  ds_read_b128 v[156:159], v4 offset:2576
  ds_read_b128 v[160:163], v4 offset:1024
  ds_read_b128 v[168:171], v4 offset:3072
  ds_read_b128 v[164:167], v4 offset:1040
  ds_read_b128 v[172:175], v4 offset:3088
  ds_read_b128 v[176:179], v4 offset:1536
  ds_read_b128 v[184:187], v4 offset:3584
  ds_read_b128 v[180:183], v4 offset:1552
  ds_read_b128 v[188:191], v4 offset:3600
  s_waitcnt lgkmcnt(12)
  v_pk_fma_f32 v[48:49], v[48:49], v[136:137], v[128:129]
  v_pk_fma_f32 v[50:51], v[50:51], v[138:139], v[130:131]
  v_pk_fma_f32 v[52:53], v[52:53], v[140:141], v[132:133]
  v_pk_fma_f32 v[54:55], v[54:55], v[142:143], v[134:135]
  v_cvt_pk_bf16_f32 v16, v48, v49
  v_cvt_pk_bf16_f32 v17, v50, v51
  v_cvt_pk_bf16_f32 v18, v52, v53
  v_cvt_pk_bf16_f32 v19, v54, v55
  ds_write_b128 v5, v[16:19] offset:0
  v_pk_fma_f32 v[80:81], v[80:81], v[136:137], v[128:129]
  v_pk_fma_f32 v[82:83], v[82:83], v[138:139], v[130:131]
  v_pk_fma_f32 v[84:85], v[84:85], v[140:141], v[132:133]
  v_pk_fma_f32 v[86:87], v[86:87], v[142:143], v[134:135]
  v_cvt_pk_bf16_f32 v32, v80, v81
  v_cvt_pk_bf16_f32 v33, v82, v83
  v_cvt_pk_bf16_f32 v34, v84, v85
  v_cvt_pk_bf16_f32 v35, v86, v87
  ds_write_b128 v5, v[32:35] offset:64
  s_waitcnt lgkmcnt(10)
  v_pk_fma_f32 v[56:57], v[56:57], v[152:153], v[144:145]
  v_pk_fma_f32 v[58:59], v[58:59], v[154:155], v[146:147]
  v_pk_fma_f32 v[60:61], v[60:61], v[156:157], v[148:149]
  v_pk_fma_f32 v[62:63], v[62:63], v[158:159], v[150:151]
  v_cvt_pk_bf16_f32 v20, v56, v57
  v_cvt_pk_bf16_f32 v21, v58, v59
  v_cvt_pk_bf16_f32 v22, v60, v61
  v_cvt_pk_bf16_f32 v23, v62, v63
  ds_write_b128 v5, v[20:23] offset:8448
  v_pk_fma_f32 v[88:89], v[88:89], v[152:153], v[144:145]
  v_pk_fma_f32 v[90:91], v[90:91], v[154:155], v[146:147]
  v_pk_fma_f32 v[92:93], v[92:93], v[156:157], v[148:149]
  v_pk_fma_f32 v[94:95], v[94:95], v[158:159], v[150:151]
  v_cvt_pk_bf16_f32 v36, v88, v89
  v_cvt_pk_bf16_f32 v37, v90, v91
  v_cvt_pk_bf16_f32 v38, v92, v93
  v_cvt_pk_bf16_f32 v39, v94, v95
  ds_write_b128 v5, v[36:39] offset:8512
  s_waitcnt lgkmcnt(8)
  v_pk_fma_f32 v[64:65], v[64:65], v[168:169], v[160:161]
  v_pk_fma_f32 v[66:67], v[66:67], v[170:171], v[162:163]
  v_pk_fma_f32 v[68:69], v[68:69], v[172:173], v[164:165]
  v_pk_fma_f32 v[70:71], v[70:71], v[174:175], v[166:167]
  v_cvt_pk_bf16_f32 v24, v64, v65
  v_cvt_pk_bf16_f32 v25, v66, v67
  v_cvt_pk_bf16_f32 v26, v68, v69
  v_cvt_pk_bf16_f32 v27, v70, v71
  ds_write_b128 v5, v[24:27] offset:16896
  v_pk_fma_f32 v[96:97], v[96:97], v[168:169], v[160:161]
  v_pk_fma_f32 v[98:99], v[98:99], v[170:171], v[162:163]
  v_pk_fma_f32 v[100:101], v[100:101], v[172:173], v[164:165]
  v_pk_fma_f32 v[102:103], v[102:103], v[174:175], v[166:167]
  v_cvt_pk_bf16_f32 v40, v96, v97
  v_cvt_pk_bf16_f32 v41, v98, v99
  v_cvt_pk_bf16_f32 v42, v100, v101
  v_cvt_pk_bf16_f32 v43, v102, v103
  ds_write_b128 v5, v[40:43] offset:16960
  s_waitcnt lgkmcnt(6)
  v_pk_fma_f32 v[72:73], v[72:73], v[184:185], v[176:177]
  v_pk_fma_f32 v[74:75], v[74:75], v[186:187], v[178:179]
  v_pk_fma_f32 v[76:77], v[76:77], v[188:189], v[180:181]
  v_pk_fma_f32 v[78:79], v[78:79], v[190:191], v[182:183]
  v_cvt_pk_bf16_f32 v28, v72, v73
  v_cvt_pk_bf16_f32 v29, v74, v75
  v_cvt_pk_bf16_f32 v30, v76, v77
  v_cvt_pk_bf16_f32 v31, v78, v79
  ds_write_b128 v5, v[28:31] offset:25344
  v_pk_fma_f32 v[104:105], v[104:105], v[184:185], v[176:177]
  v_pk_fma_f32 v[106:107], v[106:107], v[186:187], v[178:179]
  v_pk_fma_f32 v[108:109], v[108:109], v[188:189], v[180:181]
  v_pk_fma_f32 v[110:111], v[110:111], v[190:191], v[182:183]
  v_cvt_pk_bf16_f32 v44, v104, v105
  v_cvt_pk_bf16_f32 v45, v106, v107
  v_cvt_pk_bf16_f32 v46, v108, v109
  v_cvt_pk_bf16_f32 v47, v110, v111
  ds_write_b128 v5, v[44:47] offset:25408
  v_and_b32 v4, 31, v1
  v_mul_u32_u24 v5, 528, v3
  v_lshl_add_u32 v5, v4, 4, v5
  s_mul_i32 s21, s3, 4224
  s_bfe_u32 s29, s17, 0x10001
  s_mul_i32 s29, s29, 33792
  s_add_u32 s21, s21, s29
  s_add_u32 s21, s21, 65536
  v_add_u32 v11, s21, v5
  s_mul_i32 s21, s20, 16896
  s_and_b32 s29, s3, 1
  s_mul_i32 s29, s29, 33792
  s_add_u32 s21, s21, s29
  s_add_u32 s21, s21, 65536
  v_add_u32 v5, s21, v5
  s_lshl_b32 s21, s3, 11
  v_add_u32 v12, s21, v2
  s_waitcnt lgkmcnt(0)
  s_barrier
  ds_read_b128 v[32:35], v11 offset:0
  ds_read_b128 v[36:39], v11 offset:1056
  ds_read_b128 v[40:43], v11 offset:2112
  ds_read_b128 v[44:47], v11 offset:3168
  ds_read_b128 v[48:51], v5 offset:0
  ds_read_b128 v[52:55], v5 offset:1056
  ds_read_b128 v[56:59], v5 offset:2112
  ds_read_b128 v[60:63], v5 offset:3168
  ds_read_b128 v[64:67], v5 offset:4224
  ds_read_b128 v[68:71], v5 offset:5280
  ds_read_b128 v[72:75], v5 offset:6336
  ds_read_b128 v[76:79], v5 offset:7392
  ds_read_b128 v[80:83], v5 offset:8448
  ds_read_b128 v[84:87], v5 offset:9504
  ds_read_b128 v[88:91], v5 offset:10560
  s_cmp_ge_u32 s17, 4
  s_cbranch_scc1 adaLN_cond__grouped_kv_mqa__glu_gated_swiglu__prompt_kernel_nokv
  s_waitcnt lgkmcnt(11)
  s_bitcmp1_b32 s17, 0
  s_cbranch_scc1 adaLN_cond__grouped_kv_mqa__glu_gated_swiglu__prompt_kernel_vp
  v_mfma_f32_32x32x16_bf16 v[16:31], v[112:115], v[32:35], 0
  v_mfma_f32_32x32x16_bf16 v[16:31], v[116:119], v[36:39], v[16:31]
  v_mfma_f32_32x32x16_bf16 v[16:31], v[120:123], v[40:43], v[16:31]
  v_mfma_f32_32x32x16_bf16 v[16:31], v[124:127], v[44:47], v[16:31]
  s_nop 7
  s_nop 3
  s_branch adaLN_cond__grouped_kv_mqa__glu_gated_swiglu__prompt_kernel_kvw
adaLN_cond__grouped_kv_mqa__glu_gated_swiglu__prompt_kernel_vp:
  v_mfma_f32_32x32x16_bf16 v[16:31], v[32:35], v[112:115], 0
  v_mfma_f32_32x32x16_bf16 v[16:31], v[36:39], v[116:119], v[16:31]
  v_mfma_f32_32x32x16_bf16 v[16:31], v[40:43], v[120:123], v[16:31]
  v_mfma_f32_32x32x16_bf16 v[16:31], v[44:47], v[124:127], v[16:31]
  v_cmp_eq_u32 vcc, 1, v10
  s_nop 7
  s_nop 2
  v_cndmask_b32 v16, v16, v24, vcc
  v_cndmask_b32 v17, v17, v25, vcc
  v_cndmask_b32 v18, v18, v26, vcc
  v_cndmask_b32 v19, v19, v27, vcc
  v_cndmask_b32 v20, v20, v28, vcc
  v_cndmask_b32 v21, v21, v29, vcc
  v_cndmask_b32 v22, v22, v30, vcc
  v_cndmask_b32 v23, v23, v31, vcc
adaLN_cond__grouped_kv_mqa__glu_gated_swiglu__prompt_kernel_kvw:
  ds_write_b128 v13, v[16:19]
  ds_write_b128 v13, v[20:23] offset:1024
  s_waitcnt lgkmcnt(0)
  s_barrier
  s_cmp_lg_u32 s3, 0
  s_cbranch_scc1 adaLN_cond__grouped_kv_mqa__glu_gated_swiglu__prompt_kernel_nokv
  ds_read_b128 v[128:131], v13 offset:0
  ds_read_b128 v[132:135], v13 offset:1024
  ds_read_b128 v[136:139], v13 offset:2048
  ds_read_b128 v[140:143], v13 offset:3072
  ds_read_b128 v[144:147], v13 offset:4096
  ds_read_b128 v[148:151], v13 offset:5120
  ds_read_b128 v[152:155], v13 offset:6144
  ds_read_b128 v[156:159], v13 offset:7168
  ds_read_b128 v[160:163], v13 offset:8192
  ds_read_b128 v[164:167], v13 offset:9216
  ds_read_b128 v[168:171], v13 offset:10240
  ds_read_b128 v[172:175], v13 offset:11264
  ds_read_b128 v[176:179], v13 offset:12288
  ds_read_b128 v[180:183], v13 offset:13312
  ds_read_b128 v[184:187], v13 offset:14336
  ds_read_b128 v[188:191], v13 offset:15360
  v_lshlrev_b32 v14, 4, v7
  v_lshl_add_u32 v14, v10, 9, v14
  v_lshl_add_u32 v14, v3, 8, v14
  s_bitcmp1_b32 s17, 0
  s_cselect_b64 vcc, -1, 0
  s_cselect_b32 s29, 65536, 0
  s_add_u32 s29, s29, 393216
  s_lshl_b32 s21, s16, 11
  v_cndmask_b32 v14, v2, v14, vcc
  s_add_u32 s21, s21, s29
  s_bfe_u32 s29, s17, 0x10001
  s_lshl_b32 s29, s29, 10
  s_add_u32 s21, s21, s29
  s_waitcnt lgkmcnt(0)
  v_add_f32 v128, v128, v160
  v_add_f32 v129, v129, v161
  v_add_f32 v130, v130, v162
  v_add_f32 v131, v131, v163
  v_add_f32 v132, v132, v164
  v_add_f32 v133, v133, v165
  v_add_f32 v134, v134, v166
  v_add_f32 v135, v135, v167
  v_add_f32 v136, v136, v168
  v_add_f32 v137, v137, v169
  v_add_f32 v138, v138, v170
  v_add_f32 v139, v139, v171
  v_add_f32 v140, v140, v172
  v_add_f32 v141, v141, v173
  v_add_f32 v142, v142, v174
  v_add_f32 v143, v143, v175
  v_add_f32 v144, v144, v176
  v_add_f32 v145, v145, v177
  v_add_f32 v146, v146, v178
  v_add_f32 v147, v147, v179
  v_add_f32 v148, v148, v180
  v_add_f32 v149, v149, v181
  v_add_f32 v150, v150, v182
  v_add_f32 v151, v151, v183
  v_add_f32 v152, v152, v184
  v_add_f32 v153, v153, v185
  v_add_f32 v154, v154, v186
  v_add_f32 v155, v155, v187
  v_add_f32 v156, v156, v188
  v_add_f32 v157, v157, v189
  v_add_f32 v158, v158, v190
  v_add_f32 v159, v159, v191
  v_add_f32 v128, v128, v144
  v_add_f32 v129, v129, v145
  v_add_f32 v130, v130, v146
  v_add_f32 v131, v131, v147
  v_add_f32 v132, v132, v148
  v_add_f32 v133, v133, v149
  v_add_f32 v134, v134, v150
  v_add_f32 v135, v135, v151
  v_add_f32 v136, v136, v152
  v_add_f32 v137, v137, v153
  v_add_f32 v138, v138, v154
  v_add_f32 v139, v139, v155
  v_add_f32 v140, v140, v156
  v_add_f32 v141, v141, v157
  v_add_f32 v142, v142, v158
  v_add_f32 v143, v143, v159
  v_add_f32 v128, v128, v136
  v_add_f32 v129, v129, v137
  v_add_f32 v130, v130, v138
  v_add_f32 v131, v131, v139
  v_add_f32 v132, v132, v140
  v_add_f32 v133, v133, v141
  v_add_f32 v134, v134, v142
  v_add_f32 v135, v135, v143
  v_cvt_pk_bf16_f32 v136, v128, v129
  v_cvt_pk_bf16_f32 v137, v130, v131
  v_cvt_pk_bf16_f32 v138, v132, v133
  v_cvt_pk_bf16_f32 v139, v134, v135
  buffer_store_dwordx4 v[136:139], v14, s[4:7], s21 offen sc1
  s_lshl_b32 s21, s16, 2
  s_add_u32 s21, s21, s17
  s_lshl_b32 s21, s21, 2
  s_add_u32 s21, s21, 294912
  s_waitcnt vmcnt(0)
  s_mov_b64 exec, 255
  v_lshlrev_b32 v128, 9, v1
  v_mov_b32 v129, s42
  buffer_store_dword v129, v128, s[4:7], s21 offen sc1
  s_mov_b64 exec, -1
adaLN_cond__grouped_kv_mqa__glu_gated_swiglu__prompt_kernel_nokv:
  ds_read_b128 v[92:95], v5 offset:11616
  ds_read_b128 v[96:99], v5 offset:12672
  ds_read_b128 v[100:103], v5 offset:13728
  ds_read_b128 v[104:107], v5 offset:14784
  ds_read_b128 v[108:111], v5 offset:15840
  s_waitcnt lgkmcnt(15)
  v_mfma_f32_32x32x16_bf16 v[16:31], v[192:195], v[48:51], 0
  s_waitcnt lgkmcnt(14)
  v_mfma_f32_32x32x16_bf16 v[16:31], v[196:199], v[52:55], v[16:31]
  s_waitcnt lgkmcnt(13)
  v_mfma_f32_32x32x16_bf16 v[16:31], v[200:203], v[56:59], v[16:31]
  s_waitcnt lgkmcnt(12)
  v_mfma_f32_32x32x16_bf16 v[16:31], v[204:207], v[60:63], v[16:31]
  s_waitcnt lgkmcnt(11)
  v_mfma_f32_32x32x16_bf16 v[16:31], v[208:211], v[64:67], v[16:31]
  s_waitcnt lgkmcnt(10)
  v_mfma_f32_32x32x16_bf16 v[16:31], v[212:215], v[68:71], v[16:31]
  s_waitcnt lgkmcnt(9)
  v_mfma_f32_32x32x16_bf16 v[16:31], v[216:219], v[72:75], v[16:31]
  s_waitcnt lgkmcnt(8)
  v_mfma_f32_32x32x16_bf16 v[16:31], v[220:223], v[76:79], v[16:31]
  s_waitcnt lgkmcnt(7)
  v_mfma_f32_32x32x16_bf16 v[16:31], v[224:227], v[80:83], v[16:31]
  s_waitcnt lgkmcnt(6)
  v_mfma_f32_32x32x16_bf16 v[16:31], v[228:231], v[84:87], v[16:31]
  s_waitcnt lgkmcnt(5)
  v_mfma_f32_32x32x16_bf16 v[16:31], v[232:235], v[88:91], v[16:31]
  s_waitcnt lgkmcnt(4)
  v_mfma_f32_32x32x16_bf16 v[16:31], v[236:239], v[92:95], v[16:31]
  s_waitcnt lgkmcnt(3)
  v_mfma_f32_32x32x16_bf16 v[16:31], v[240:243], v[96:99], v[16:31]
  s_waitcnt lgkmcnt(2)
  v_mfma_f32_32x32x16_bf16 v[16:31], v[244:247], v[100:103], v[16:31]
  s_waitcnt lgkmcnt(1)
  v_mfma_f32_32x32x16_bf16 v[16:31], v[248:251], v[104:107], v[16:31]
  s_waitcnt lgkmcnt(0)
  v_mfma_f32_32x32x16_bf16 v[16:31], v[252:255], v[108:111], v[16:31]
  s_cmp_eq_u32 s20, 1
  s_cselect_b64 vcc, -1, 0
  s_xor_b32 s21, s3, 4
  s_lshl_b32 s21, s21, 11
  v_add_u32 v11, s21, v2
  s_nop 7
  v_cndmask_b32 v32, v24, v16, vcc
  v_cndmask_b32 v16, v16, v24, vcc
  v_cndmask_b32 v33, v25, v17, vcc
  v_cndmask_b32 v17, v17, v25, vcc
  v_cndmask_b32 v34, v26, v18, vcc
  v_cndmask_b32 v18, v18, v26, vcc
  v_cndmask_b32 v35, v27, v19, vcc
  v_cndmask_b32 v19, v19, v27, vcc
  v_cndmask_b32 v36, v28, v20, vcc
  v_cndmask_b32 v20, v20, v28, vcc
  v_cndmask_b32 v37, v29, v21, vcc
  v_cndmask_b32 v21, v21, v29, vcc
  v_cndmask_b32 v38, v30, v22, vcc
  v_cndmask_b32 v22, v22, v30, vcc
  v_cndmask_b32 v39, v31, v23, vcc
  v_cndmask_b32 v23, v23, v31, vcc
  ds_write_b128 v11, v[32:35]
  ds_write_b128 v11, v[36:39] offset:1024
  s_waitcnt lgkmcnt(0)
  s_barrier
  ds_read_b128 v[32:35], v12
  ds_read_b128 v[36:39], v12 offset:1024
  s_mov_b32 s21, 0x3eb8aa3b
  s_waitcnt lgkmcnt(0)
  v_add_f32 v16, v16, v32
  v_add_f32 v17, v17, v33
  v_add_f32 v18, v18, v34
  v_add_f32 v19, v19, v35
  v_add_f32 v20, v20, v36
  v_add_f32 v21, v21, v37
  v_add_f32 v22, v22, v38
  v_add_f32 v23, v23, v39
  v_mul_f32 v16, s21, v16
  v_mul_f32 v17, s21, v17
  v_mul_f32 v18, s21, v18
  v_mul_f32 v19, s21, v19
  v_mul_f32 v20, s21, v20
  v_mul_f32 v21, s21, v21
  v_mul_f32 v22, s21, v22
  v_mul_f32 v23, s21, v23
  v_cvt_pk_bf16_f32 v4, v16, v17
  v_cvt_pk_bf16_f32 v5, v18, v19
  v_cvt_pk_bf16_f32 v6, v20, v21
  v_cvt_pk_bf16_f32 v7, v22, v23
  s_cmp_lg_u32 s3, 7
  s_cbranch_scc1 adaLN_cond__grouped_kv_mqa__glu_gated_swiglu__prompt_kernel_nop3
  v_lshlrev_b32 v8, 2, v1
  s_mov_b32 s21, 368640
  s_mov_b32 s30, 0
adaLN_cond__grouped_kv_mqa__glu_gated_swiglu__prompt_kernel_poll2:
  buffer_load_dword v10, v8, s[4:7], s21 offen offset:0 sc1
  s_add_u32 s30, s30, 1
  s_waitcnt vmcnt(0)
  v_cmp_ne_u32 vcc, s42, v10
  s_nop 1
  s_cbranch_vccz adaLN_cond__grouped_kv_mqa__glu_gated_swiglu__prompt_kernel_poll2d
  s_sleep 1
  s_cmp_lt_u32 s30, 0x20000
  s_cbranch_scc1 adaLN_cond__grouped_kv_mqa__glu_gated_swiglu__prompt_kernel_poll2
adaLN_cond__grouped_kv_mqa__glu_gated_swiglu__prompt_kernel_poll2d:
  v_lshlrev_b32 v8, 3, v1
  s_and_b32 s21, s2, 7
  s_lshl_b32 s21, s21, 9
  s_add_u32 s21, s21, 294912
  s_mov_b32 s30, 0
adaLN_cond__grouped_kv_mqa__glu_gated_swiglu__prompt_kernel_poll3:
  buffer_load_dwordx2 v[10:11], v8, s[4:7], s21 offen offset:0 sc1
  s_add_u32 s30, s30, 1
  s_waitcnt vmcnt(0)
  v_xor_b32 v10, s42, v10
  v_xor_b32 v11, s42, v11
  v_or_b32 v10, v10, v11
  v_cmp_ne_u32 vcc, 0, v10
  s_nop 1
  s_cbranch_vccz adaLN_cond__grouped_kv_mqa__glu_gated_swiglu__prompt_kernel_poll3d
  s_sleep 1
  s_cmp_lt_u32 s30, 0x20000
  s_cbranch_scc1 adaLN_cond__grouped_kv_mqa__glu_gated_swiglu__prompt_kernel_poll3
adaLN_cond__grouped_kv_mqa__glu_gated_swiglu__prompt_kernel_poll3d:
adaLN_cond__grouped_kv_mqa__glu_gated_swiglu__prompt_kernel_nop3:
  s_mov_b32 s34, 0
  s_cmp_ge_u32 s2, 192
  s_cbranch_scc1 adaLN_cond__grouped_kv_mqa__glu_gated_swiglu__prompt_kernel_pkdone
  s_cmp_ge_u32 s2, 128
  s_cbranch_scc1 adaLN_cond__grouped_kv_mqa__glu_gated_swiglu__prompt_kernel_pw2
  s_and_b32 s36, s2, 7
  s_lshl_b32 s36, s36, 2
  s_and_b32 s25, s17, 3
  s_add_u32 s36, s36, s25
  s_and_b32 s25, s2, 0xe0
  s_add_u32 s36, s36, s25
  s_mov_b32 s31, s36
  s_cmp_ge_u32 s36, 112
  s_cbranch_scc1 adaLN_cond__grouped_kv_mqa__glu_gated_swiglu__prompt_kernel_pwo
  s_mov_b32 s8, s44
  s_mov_b32 s9, s45
  s_mov_b32 s10, 0x1c0000
  s_mov_b32 s11, 0x20000
  s_mov_b32 s12, s46
  s_mov_b32 s13, s47
  s_mov_b32 s14, 0x1c0000
  s_mov_b32 s15, 0x20000
  s_mul_i32 s25, s3, 229376
  s_lshl_b32 s26, s36, 5
  s_add_u32 s25, s25, s26
  s_mov_b32 s26, s25
  s_mov_b32 s27, 3584
  s_lshl_b32 s35, s36, 15
  s_add_u32 s35, s35, 3145728
  s_mov_b32 s34, 1
  s_branch adaLN_cond__grouped_kv_mqa__glu_gated_swiglu__prompt_kernel_pkgo
adaLN_cond__grouped_kv_mqa__glu_gated_swiglu__prompt_kernel_pwo:
  s_mov_b32 s8, s40
  s_mov_b32 s9, s41
  s_mov_b32 s10, 0x80000
  s_mov_b32 s11, 0x20000
  s_mov_b32 s12, s40
  s_mov_b32 s13, s41
  s_mov_b32 s14, 0x80000
  s_mov_b32 s15, 0x20000
  s_sub_u32 s35, s36, 112
  s_lshl_b32 s25, s35, 6
  s_lshl_b32 s35, s35, 15
  s_add_u32 s35, s35, 2097152
  s_branch adaLN_cond__grouped_kv_mqa__glu_gated_swiglu__prompt_kernel_pk1k
adaLN_cond__grouped_kv_mqa__glu_gated_swiglu__prompt_kernel_pw2:
  s_mov_b32 s8, s48
  s_mov_b32 s9, s49
  s_mov_b32 s10, 0x1c0000
  s_mov_b32 s11, 0x20000
  s_mov_b32 s12, s48
  s_mov_b32 s13, s49
  s_mov_b32 s14, 0x1c0000
  s_mov_b32 s15, 0x20000
  s_and_b32 s25, s2, 7
  s_lshl_b32 s25, s25, 1
  s_bfe_u32 s26, s2, 0x10003
  s_add_u32 s25, s25, s26
  s_bfe_u32 s26, s2, 0x20004
  s_lshl_b32 s31, s25, 2
  s_add_u32 s31, s31, s26
  s_add_u32 s31, s31, 128
  s_cmp_eq_u32 s3, 7
  s_cbranch_scc1 adaLN_cond__grouped_kv_mqa__glu_gated_swiglu__prompt_kernel_pkdone
  s_mul_i32 s35, s25, 114688
  s_mul_i32 s27, s26, 28672
  s_add_u32 s35, s35, s27
  s_add_u32 s35, s35, 7340032
  s_lshl_b32 s25, s25, 6
  s_mul_i32 s26, s26, 458752
  s_add_u32 s25, s25, s26
adaLN_cond__grouped_kv_mqa__glu_gated_swiglu__prompt_kernel_pk1k:
  s_lshl_b32 s26, s3, 16
  s_add_u32 s25, s25, s26
  s_add_u32 s26, s25, 32
  s_mov_b32 s27, 1024
  s_mov_b32 s34, 2
adaLN_cond__grouped_kv_mqa__glu_gated_swiglu__prompt_kernel_pkgo:
  s_lshl_b32 s37, s3, 12
  s_add_u32 s35, s35, s37
  s_add_u32 s37, s37, 131072
adaLN_cond__grouped_kv_mqa__glu_gated_swiglu__prompt_kernel_pkdone:
  s_barrier
  s_lshl_b32 s18, s3, 11
  s_add_u32 s19, s18, 393216
  s_add_u32 m0, s18, 0
  s_add_u32 s21, s19, 0
  buffer_load_dwordx4 v2, s[4:7], s21 offen sc1 lds
  buffer_load_dwordx4 v2, s[4:7], s21 offen offset:1024 sc1 lds
  s_add_u32 m0, s18, 65536
  s_add_u32 s21, s19, 65536
  buffer_load_dwordx4 v2, s[4:7], s21 offen sc1 lds
  buffer_load_dwordx4 v2, s[4:7], s21 offen offset:1024 sc1 lds
  s_barrier
  s_add_u32 m0, s18, 16384
  s_add_u32 s21, s19, 16384
  buffer_load_dwordx4 v2, s[4:7], s21 offen sc1 lds
  buffer_load_dwordx4 v2, s[4:7], s21 offen offset:1024 sc1 lds
  s_add_u32 m0, s18, 81920
  s_add_u32 s21, s19, 81920
  buffer_load_dwordx4 v2, s[4:7], s21 offen sc1 lds
  buffer_load_dwordx4 v2, s[4:7], s21 offen offset:1024 sc1 lds
  s_add_u32 m0, s18, 32768
  s_add_u32 s21, s19, 32768
  buffer_load_dwordx4 v2, s[4:7], s21 offen sc1 lds
  buffer_load_dwordx4 v2, s[4:7], s21 offen offset:1024 sc1 lds
  s_add_u32 m0, s18, 98304
  s_add_u32 s21, s19, 98304
  buffer_load_dwordx4 v2, s[4:7], s21 offen sc1 lds
  buffer_load_dwordx4 v2, s[4:7], s21 offen offset:1024 sc1 lds
  s_add_u32 m0, s18, 49152
  s_add_u32 s21, s19, 49152
  buffer_load_dwordx4 v2, s[4:7], s21 offen sc1 lds
  buffer_load_dwordx4 v2, s[4:7], s21 offen offset:1024 sc1 lds
  s_add_u32 m0, s18, 114688
  s_add_u32 s21, s19, 114688
  buffer_load_dwordx4 v2, s[4:7], s21 offen sc1 lds
  buffer_load_dwordx4 v2, s[4:7], s21 offen offset:1024 sc1 lds
  s_mov_b32 s38, s25
  s_mov_b32 s39, s26
  s_mov_b32 s43, s27
  v_and_b32 v44, 15, v1
  v_lshlrev_b32 v44, 4, v44
  v_lshl_add_u32 v44, v3, 8, v44
  v_add_u32 v44, 65536, v44
  v_and_b32 v40, 27, v1
  v_cmp_eq_u32 vcc, 16, v40
  v_mov_b32 v41, 0x3f803f80
  s_nop 0
  v_cndmask_b32 v40, 0, v41, vcc
  v_mov_b32 v16, v40
  v_mov_b32 v17, v40
  v_mov_b32 v18, v40
  v_mov_b32 v19, v40
  v_mov_b32 v20, v40
  v_mov_b32 v21, v40
  v_mov_b32 v22, v40
  v_mov_b32 v23, v40
  v_mov_b32 v24, v40
  v_mov_b32 v25, v40
  v_mov_b32 v26, v40
  v_mov_b32 v27, v40
  v_mov_b32 v28, v40
  v_mov_b32 v29, v40
  v_mov_b32 v30, v40
  v_mov_b32 v31, v40
  s_mov_b32 s22, 0x0000ffff
  s_mov_b32 s23, 0x0000ffff
  s_mov_b32 s24, 4
  s_mov_b32 s25, 0x42c00000
  s_mov_b32 s26, 0
  s_waitcnt vmcnt(12)
  s_barrier
  s_cmp_eq_u32 s34, 0
  s_cbranch_scc1 adaLN_cond__grouped_kv_mqa__glu_gated_swiglu__prompt_kernel_restart
  s_and_b32 s21, s17, 3
  s_lshl_b32 s21, s21, 4
  v_and_or_b32 v126, v1, 15, s21
  v_xor_b32 v127, 32, v126
  v_mul_lo_u32 v126, v126, s43
  v_mul_lo_u32 v127, v127, s43
  buffer_load_dword v126, v126, s[8:11], s38 offen
  buffer_load_dword v127, v127, s[12:15], s39 offen
adaLN_cond__grouped_kv_mqa__glu_gated_swiglu__prompt_kernel_restart:
  v_mov_b32 v40, v2
  v_mov_b32 v41, 0xff7fffff
  s_mov_b32 s27, 0
adaLN_cond__grouped_kv_mqa__glu_gated_swiglu__prompt_kernel_mx:
  ds_read_b128 v[8:11], v40
  ds_read_b128 v[12:15], v40 offset:1024
  v_add_u32 v40, 2048, v40
  s_waitcnt lgkmcnt(1)
  v_mfma_f32_32x32x16_bf16 v[80:95], v[8:11], v[4:7], 0
  s_waitcnt lgkmcnt(0)
  v_mfma_f32_32x32x16_bf16 v[96:111], v[12:15], v[4:7], 0
  s_nop 7
  s_nop 2
  v_max3_f32 v41, v80, v81, v41
  v_max3_f32 v41, v82, v83, v41
  v_max3_f32 v41, v84, v85, v41
  v_max3_f32 v41, v86, v87, v41
  v_max3_f32 v41, v88, v89, v41
  v_max3_f32 v41, v90, v91, v41
  v_max3_f32 v41, v92, v93, v41
  v_max3_f32 v41, v94, v95, v41
  v_max3_f32 v41, v96, v97, v41
  v_max3_f32 v41, v98, v99, v41
  v_max3_f32 v41, v100, v101, v41
  v_max3_f32 v41, v102, v103, v41
  v_max3_f32 v41, v104, v105, v41
  v_max3_f32 v41, v106, v107, v41
  v_max3_f32 v41, v108, v109, v41
  v_max3_f32 v41, v110, v111, v41
  s_add_u32 s27, s27, 2
  s_cmp_lt_u32 s27, s24
  s_cbranch_scc1 adaLN_cond__grouped_kv_mqa__glu_gated_swiglu__prompt_kernel_mx
  v_mov_b32 v40, v41
  s_nop 1
  v_permlane32_swap_b32 v40, v41
  v_max_f32 v40, v40, v41
  v_add_f32 v40, s25, v40
  v_mov_b32 v42, v2
  v_mov_b32 v43, v44
  ds_read_b128 v[8:11], v42
  ds_read_b128 v[12:15], v42 offset:1024
  s_mov_b64 exec, s[22:23]
  ds_read_b128 v[16:19], v43
  ds_read_b128 v[20:23], v43 offset:512
  ds_read_b128 v[28:31], v43 offset:512
  s_mov_b64 exec, -1
  v_sub_f32 v64, 0, v40
  v_sub_f32 v65, 0, v40
  v_sub_f32 v66, 0, v40
  v_sub_f32 v67, 0, v40
  v_sub_f32 v68, 0, v40
  v_sub_f32 v69, 0, v40
  v_sub_f32 v70, 0, v40
  v_sub_f32 v71, 0, v40
  v_sub_f32 v72, 0, v40
  v_sub_f32 v73, 0, v40
  v_sub_f32 v74, 0, v40
  v_sub_f32 v75, 0, v40
  v_sub_f32 v76, 0, v40
  v_sub_f32 v77, 0, v40
  v_sub_f32 v78, 0, v40
  v_sub_f32 v79, 0, v40
  v_mov_b32 v110, 0
  v_mov_b32 v111, 0
  s_waitcnt lgkmcnt(0)
  v_mfma_f32_32x32x16_bf16 v[80:95], v[8:11], v[4:7], v[64:79]
  s_mov_b32 s27, 0
  s_setprio 1
  v_mov_b32 v48, 0
  v_mov_b32 v49, 0
  v_mov_b32 v50, 0
  v_mov_b32 v51, 0
  v_mov_b32 v52, 0
  v_mov_b32 v53, 0
  v_mov_b32 v54, 0
  v_mov_b32 v55, 0
  v_mov_b32 v56, 0
  v_mov_b32 v57, 0
  v_mov_b32 v58, 0
  v_mov_b32 v59, 0
  v_mov_b32 v60, 0
  v_mov_b32 v61, 0
  v_mov_b32 v62, 0
  v_mov_b32 v63, 0
  v_mov_b32 v36, 0
  v_mov_b32 v37, 0
  v_mov_b32 v38, 0
  s_cmp_eq_u32 s20, 0
  s_cbranch_scc1 adaLN_cond__grouped_kv_mqa__glu_gated_swiglu__prompt_kernel_pr1
  s_setprio 2
adaLN_cond__grouped_kv_mqa__glu_gated_swiglu__prompt_kernel_pr1:
  .p2align 6
adaLN_cond__grouped_kv_mqa__glu_gated_swiglu__prompt_kernel_loop:
  v_exp_f32 v80, v80
  v_cvt_pk_bf16_f32 v39, v110, v111
  v_exp_f32 v81, v81
  v_exp_f32 v82, v82
  v_mfma_f32_32x32x16_bf16 v[48:63], v[28:31], v[36:39], v[48:63]
  v_cvt_pk_bf16_f32 v32, v80, v81
  v_exp_f32 v83, v83
  s_waitcnt lgkmcnt(0)
  ds_read_b128 v[8:11], v42 offset:2048
  s_mov_b64 exec, s[22:23]
  ds_read_b128 v[24:27], v43 offset:1024
  ds_read_b128 v[28:31], v43 offset:1536
  s_mov_b64 exec, -1
  v_exp_f32 v84, v84
  v_cvt_pk_bf16_f32 v33, v82, v83
  v_exp_f32 v85, v85
  v_exp_f32 v86, v86
  v_cvt_pk_bf16_f32 v34, v84, v85
  v_mfma_f32_32x32x16_bf16 v[96:111], v[12:15], v[4:7], v[64:79]
  v_exp_f32 v87, v87
  v_exp_f32 v88, v88
  v_cvt_pk_bf16_f32 v35, v86, v87
  v_exp_f32 v89, v89
  v_exp_f32 v90, v90
  v_mfma_f32_32x32x16_bf16 v[48:63], v[16:19], v[32:35], v[48:63]
  v_cvt_pk_bf16_f32 v36, v88, v89
  v_exp_f32 v91, v91
  v_exp_f32 v92, v92
  v_cvt_pk_bf16_f32 v37, v90, v91
  v_exp_f32 v93, v93
  v_exp_f32 v94, v94
  v_cvt_pk_bf16_f32 v38, v92, v93
  v_exp_f32 v95, v95
  v_exp_f32 v96, v96
  v_cvt_pk_bf16_f32 v39, v94, v95
  v_exp_f32 v97, v97
  v_exp_f32 v98, v98
  v_mfma_f32_32x32x16_bf16 v[48:63], v[20:23], v[36:39], v[48:63]
  v_cvt_pk_bf16_f32 v32, v96, v97
  v_exp_f32 v99, v99
  s_waitcnt lgkmcnt(0)
  ds_read_b128 v[12:15], v42 offset:3072
  s_mov_b64 exec, s[22:23]
  ds_read_b128 v[16:19], v43 offset:2048
  ds_read_b128 v[20:23], v43 offset:2560
  s_mov_b64 exec, -1
  v_exp_f32 v100, v100
  v_cvt_pk_bf16_f32 v33, v98, v99
  v_exp_f32 v101, v101
  v_exp_f32 v102, v102
  v_cvt_pk_bf16_f32 v34, v100, v101
  v_mfma_f32_32x32x16_bf16 v[80:95], v[8:11], v[4:7], v[64:79]
  v_exp_f32 v103, v103
  v_exp_f32 v104, v104
  v_cvt_pk_bf16_f32 v35, v102, v103
  v_exp_f32 v105, v105
  v_exp_f32 v106, v106
  v_mfma_f32_32x32x16_bf16 v[48:63], v[24:27], v[32:35], v[48:63]
  v_cvt_pk_bf16_f32 v36, v104, v105
  v_exp_f32 v107, v107
  v_exp_f32 v108, v108
  v_cvt_pk_bf16_f32 v37, v106, v107
  v_exp_f32 v109, v109
  v_exp_f32 v110, v110
  v_cvt_pk_bf16_f32 v38, v108, v109
  v_exp_f32 v111, v111
  v_exp_f32 v80, v80
  v_cvt_pk_bf16_f32 v39, v110, v111
  v_exp_f32 v81, v81
  v_exp_f32 v82, v82
  v_mfma_f32_32x32x16_bf16 v[48:63], v[28:31], v[36:39], v[48:63]
  v_cvt_pk_bf16_f32 v32, v80, v81
  v_exp_f32 v83, v83
  s_waitcnt lgkmcnt(0)
  ds_read_b128 v[8:11], v42 offset:4096
  s_mov_b64 exec, s[22:23]
  ds_read_b128 v[24:27], v43 offset:3072
  ds_read_b128 v[28:31], v43 offset:3584
  s_mov_b64 exec, -1
  v_exp_f32 v84, v84
  v_cvt_pk_bf16_f32 v33, v82, v83
  v_exp_f32 v85, v85
  v_exp_f32 v86, v86
  v_cvt_pk_bf16_f32 v34, v84, v85
  v_mfma_f32_32x32x16_bf16 v[96:111], v[12:15], v[4:7], v[64:79]
  v_exp_f32 v87, v87
  v_exp_f32 v88, v88
  v_cvt_pk_bf16_f32 v35, v86, v87
  v_exp_f32 v89, v89
  v_exp_f32 v90, v90
  v_mfma_f32_32x32x16_bf16 v[48:63], v[16:19], v[32:35], v[48:63]
  v_cvt_pk_bf16_f32 v36, v88, v89
  v_exp_f32 v91, v91
  v_exp_f32 v92, v92
  v_cvt_pk_bf16_f32 v37, v90, v91
  v_exp_f32 v93, v93
  v_exp_f32 v94, v94
  v_cvt_pk_bf16_f32 v38, v92, v93
  v_exp_f32 v95, v95
  v_exp_f32 v96, v96
  v_cvt_pk_bf16_f32 v39, v94, v95
  v_exp_f32 v97, v97
  v_exp_f32 v98, v98
  v_mfma_f32_32x32x16_bf16 v[48:63], v[20:23], v[36:39], v[48:63]
  v_cvt_pk_bf16_f32 v32, v96, v97
  v_exp_f32 v99, v99
  s_waitcnt lgkmcnt(0)
  ds_read_b128 v[12:15], v42 offset:5120
  s_mov_b64 exec, s[22:23]
  ds_read_b128 v[16:19], v43 offset:4096
  ds_read_b128 v[20:23], v43 offset:4608
  s_mov_b64 exec, -1
  v_exp_f32 v100, v100
  v_cvt_pk_bf16_f32 v33, v98, v99
  v_exp_f32 v101, v101
  v_exp_f32 v102, v102
  v_cvt_pk_bf16_f32 v34, v100, v101
  v_mfma_f32_32x32x16_bf16 v[80:95], v[8:11], v[4:7], v[64:79]
  v_exp_f32 v103, v103
  v_exp_f32 v104, v104
  v_cvt_pk_bf16_f32 v35, v102, v103
  v_exp_f32 v105, v105
  v_exp_f32 v106, v106
  v_mfma_f32_32x32x16_bf16 v[48:63], v[24:27], v[32:35], v[48:63]
  v_cvt_pk_bf16_f32 v36, v104, v105
  v_exp_f32 v107, v107
  v_exp_f32 v108, v108
  v_cvt_pk_bf16_f32 v37, v106, v107
  v_exp_f32 v109, v109
  v_exp_f32 v110, v110
  v_cvt_pk_bf16_f32 v38, v108, v109
  v_exp_f32 v111, v111
  v_exp_f32 v80, v80
  v_cvt_pk_bf16_f32 v39, v110, v111
  v_exp_f32 v81, v81
  v_exp_f32 v82, v82
  v_mfma_f32_32x32x16_bf16 v[48:63], v[28:31], v[36:39], v[48:63]
  v_cvt_pk_bf16_f32 v32, v80, v81
  v_exp_f32 v83, v83
  s_waitcnt lgkmcnt(0)
  ds_read_b128 v[8:11], v42 offset:6144
  s_mov_b64 exec, s[22:23]
  ds_read_b128 v[24:27], v43 offset:5120
  ds_read_b128 v[28:31], v43 offset:5632
  s_mov_b64 exec, -1
  v_exp_f32 v84, v84
  v_cvt_pk_bf16_f32 v33, v82, v83
  v_exp_f32 v85, v85
  v_exp_f32 v86, v86
  v_cvt_pk_bf16_f32 v34, v84, v85
  v_mfma_f32_32x32x16_bf16 v[96:111], v[12:15], v[4:7], v[64:79]
  v_exp_f32 v87, v87
  v_exp_f32 v88, v88
  v_cvt_pk_bf16_f32 v35, v86, v87
  v_exp_f32 v89, v89
  v_exp_f32 v90, v90
  v_mfma_f32_32x32x16_bf16 v[48:63], v[16:19], v[32:35], v[48:63]
  v_cvt_pk_bf16_f32 v36, v88, v89
  v_exp_f32 v91, v91
  v_exp_f32 v92, v92
  v_cvt_pk_bf16_f32 v37, v90, v91
  v_exp_f32 v93, v93
  v_exp_f32 v94, v94
  v_cvt_pk_bf16_f32 v38, v92, v93
  v_exp_f32 v95, v95
  v_exp_f32 v96, v96
  v_cvt_pk_bf16_f32 v39, v94, v95
  v_exp_f32 v97, v97
  v_exp_f32 v98, v98
  v_mfma_f32_32x32x16_bf16 v[48:63], v[20:23], v[36:39], v[48:63]
  v_cvt_pk_bf16_f32 v32, v96, v97
  v_exp_f32 v99, v99
  s_waitcnt lgkmcnt(0)
  ds_read_b128 v[12:15], v42 offset:7168
  s_mov_b64 exec, s[22:23]
  ds_read_b128 v[16:19], v43 offset:6144
  ds_read_b128 v[20:23], v43 offset:6656
  s_mov_b64 exec, -1
  v_exp_f32 v100, v100
  v_cvt_pk_bf16_f32 v33, v98, v99
  v_exp_f32 v101, v101
  v_exp_f32 v102, v102
  v_cvt_pk_bf16_f32 v34, v100, v101
  v_mfma_f32_32x32x16_bf16 v[80:95], v[8:11], v[4:7], v[64:79]
  v_exp_f32 v103, v103
  v_exp_f32 v104, v104
  v_cvt_pk_bf16_f32 v35, v102, v103
  v_exp_f32 v105, v105
  v_exp_f32 v106, v106
  v_mfma_f32_32x32x16_bf16 v[48:63], v[24:27], v[32:35], v[48:63]
  v_cvt_pk_bf16_f32 v36, v104, v105
  v_exp_f32 v107, v107
  v_exp_f32 v108, v108
  v_cvt_pk_bf16_f32 v37, v106, v107
  v_exp_f32 v109, v109
  v_exp_f32 v110, v110
  v_cvt_pk_bf16_f32 v38, v108, v109
  v_exp_f32 v111, v111
  v_exp_f32 v80, v80
  v_cvt_pk_bf16_f32 v39, v110, v111
  v_exp_f32 v81, v81
  v_exp_f32 v82, v82
  v_mfma_f32_32x32x16_bf16 v[48:63], v[28:31], v[36:39], v[48:63]
  v_cvt_pk_bf16_f32 v32, v80, v81
  v_exp_f32 v83, v83
  s_waitcnt lgkmcnt(0)
  ds_read_b128 v[8:11], v42 offset:8192
  s_mov_b64 exec, s[22:23]
  ds_read_b128 v[24:27], v43 offset:7168
  ds_read_b128 v[28:31], v43 offset:7680
  s_mov_b64 exec, -1
  v_exp_f32 v84, v84
  v_cvt_pk_bf16_f32 v33, v82, v83
  v_exp_f32 v85, v85
  v_exp_f32 v86, v86
  v_cvt_pk_bf16_f32 v34, v84, v85
  v_mfma_f32_32x32x16_bf16 v[96:111], v[12:15], v[4:7], v[64:79]
  v_exp_f32 v87, v87
  v_exp_f32 v88, v88
  v_cvt_pk_bf16_f32 v35, v86, v87
  v_exp_f32 v89, v89
  v_exp_f32 v90, v90
  v_mfma_f32_32x32x16_bf16 v[48:63], v[16:19], v[32:35], v[48:63]
  v_cvt_pk_bf16_f32 v36, v88, v89
  v_exp_f32 v91, v91
  v_exp_f32 v92, v92
  v_cvt_pk_bf16_f32 v37, v90, v91
  v_exp_f32 v93, v93
  v_exp_f32 v94, v94
  v_cvt_pk_bf16_f32 v38, v92, v93
  v_exp_f32 v95, v95
  v_exp_f32 v96, v96
  v_cvt_pk_bf16_f32 v39, v94, v95
  v_exp_f32 v97, v97
  v_exp_f32 v98, v98
  v_mfma_f32_32x32x16_bf16 v[48:63], v[20:23], v[36:39], v[48:63]
  v_cvt_pk_bf16_f32 v32, v96, v97
  v_exp_f32 v99, v99
  s_waitcnt lgkmcnt(0)
  ds_read_b128 v[12:15], v42 offset:9216
  s_mov_b64 exec, s[22:23]
  ds_read_b128 v[16:19], v43 offset:8192
  ds_read_b128 v[20:23], v43 offset:8704
  s_mov_b64 exec, -1
  v_exp_f32 v100, v100
  v_cvt_pk_bf16_f32 v33, v98, v99
  v_exp_f32 v101, v101
  v_exp_f32 v102, v102
  v_cvt_pk_bf16_f32 v34, v100, v101
  v_mfma_f32_32x32x16_bf16 v[80:95], v[8:11], v[4:7], v[64:79]
  v_exp_f32 v103, v103
  v_exp_f32 v104, v104
  v_cvt_pk_bf16_f32 v35, v102, v103
  v_exp_f32 v105, v105
  v_exp_f32 v106, v106
  v_mfma_f32_32x32x16_bf16 v[48:63], v[24:27], v[32:35], v[48:63]
  v_cvt_pk_bf16_f32 v36, v104, v105
  v_exp_f32 v107, v107
  v_exp_f32 v108, v108
  v_cvt_pk_bf16_f32 v37, v106, v107
  v_exp_f32 v109, v109
  v_exp_f32 v110, v110
  v_cvt_pk_bf16_f32 v38, v108, v109
  v_exp_f32 v111, v111
adaLN_cond__grouped_kv_mqa__glu_gated_swiglu__prompt_kernel_lnext:
  v_add_u32 v42, 8192, v42
  v_add_u32 v43, 8192, v43
  s_add_u32 s27, s27, 1
  s_add_u32 s28, s27, s26
  s_cmp_ge_u32 s28, 7
  s_cbranch_scc1 adaLN_cond__grouped_kv_mqa__glu_gated_swiglu__prompt_kernel_nobar
  s_cmp_lg_u32 s28, 1
  s_cbranch_scc1 adaLN_cond__grouped_kv_mqa__glu_gated_swiglu__prompt_kernel_nb1
  s_waitcnt vmcnt(0)
  s_barrier
  s_cmp_eq_u32 s34, 0
  s_cbranch_scc1 adaLN_cond__grouped_kv_mqa__glu_gated_swiglu__prompt_kernel_loop
  v_lshrrev_b32 v112, 1, v1
  v_mul_lo_u32 v112, v112, s43
  v_and_b32 v113, 1, v1
  v_lshl_add_u32 v112, v113, 4, v112
  s_lshl_b32 s43, s43, 5
  v_and_b32 v120, 31, v1
  v_lshlrev_b32 v121, 3, v3
  v_mov_b32 v122, 0x40000000
  v_add_u32 v123, 16384, v121
  v_add_u32 v121, 15360, v121
  v_cmp_eq_u32 vcc, 0, v120
  s_nop 1
  v_cndmask_b32 v122, v122, v123, vcc
  v_cmp_eq_u32 vcc, 1, v120
  s_lshl_b32 s40, s3, 7
  s_nop 0
  v_cndmask_b32 v122, v122, v121, vcc
  v_exp_f32 v80, v80
  v_cvt_pk_bf16_f32 v39, v110, v111
  v_exp_f32 v81, v81
  v_exp_f32 v82, v82
  v_mfma_f32_32x32x16_bf16 v[48:63], v[28:31], v[36:39], v[48:63]
  s_add_u32 m0, s37, 0
  s_nop 0
  buffer_load_dwordx4 v112, s[8:11], s38 offen lds
  v_cvt_pk_bf16_f32 v32, v80, v81
  v_exp_f32 v83, v83
  s_waitcnt lgkmcnt(0)
  ds_read_b128 v[8:11], v42 offset:2048
  s_mov_b64 exec, s[22:23]
  ds_read_b128 v[24:27], v43 offset:1024
  ds_read_b128 v[28:31], v43 offset:1536
  s_mov_b64 exec, -1
  v_exp_f32 v84, v84
  v_cvt_pk_bf16_f32 v33, v82, v83
  v_exp_f32 v85, v85
  v_exp_f32 v86, v86
  v_cvt_pk_bf16_f32 v34, v84, v85
  v_mfma_f32_32x32x16_bf16 v[96:111], v[12:15], v[4:7], v[64:79]
  v_exp_f32 v87, v87
  v_exp_f32 v88, v88
  v_cvt_pk_bf16_f32 v35, v86, v87
  v_exp_f32 v89, v89
  v_exp_f32 v90, v90
  v_mfma_f32_32x32x16_bf16 v[48:63], v[16:19], v[32:35], v[48:63]
  s_nop 0
  v_cvt_pk_bf16_f32 v36, v88, v89
  v_exp_f32 v91, v91
  v_exp_f32 v92, v92
  v_cvt_pk_bf16_f32 v37, v90, v91
  v_exp_f32 v93, v93
  v_exp_f32 v94, v94
  v_cvt_pk_bf16_f32 v38, v92, v93
  v_exp_f32 v95, v95
  v_exp_f32 v96, v96
  v_cvt_pk_bf16_f32 v39, v94, v95
  v_exp_f32 v97, v97
  v_exp_f32 v98, v98
  v_mfma_f32_32x32x16_bf16 v[48:63], v[20:23], v[36:39], v[48:63]
  buffer_load_dwordx2 v[144:145], v122, s[4:7], s40 offen offset:0 sc1
  buffer_load_dwordx2 v[146:147], v122, s[4:7], s40 offen offset:16 sc1
  v_cvt_pk_bf16_f32 v32, v96, v97
  v_exp_f32 v99, v99
  s_waitcnt lgkmcnt(0)
  ds_read_b128 v[12:15], v42 offset:3072
  s_mov_b64 exec, s[22:23]
  ds_read_b128 v[16:19], v43 offset:2048
  ds_read_b128 v[20:23], v43 offset:2560
  s_mov_b64 exec, -1
  v_exp_f32 v100, v100
  v_cvt_pk_bf16_f32 v33, v98, v99
  v_exp_f32 v101, v101
  v_exp_f32 v102, v102
  v_cvt_pk_bf16_f32 v34, v100, v101
  v_mfma_f32_32x32x16_bf16 v[80:95], v[8:11], v[4:7], v[64:79]
  v_exp_f32 v103, v103
  v_exp_f32 v104, v104
  v_cvt_pk_bf16_f32 v35, v102, v103
  v_exp_f32 v105, v105
  v_exp_f32 v106, v106
  v_mfma_f32_32x32x16_bf16 v[48:63], v[24:27], v[32:35], v[48:63]
  s_nop 0
  v_cvt_pk_bf16_f32 v36, v104, v105
  v_exp_f32 v107, v107
  v_exp_f32 v108, v108
  v_cvt_pk_bf16_f32 v37, v106, v107
  v_exp_f32 v109, v109
  v_exp_f32 v110, v110
  v_cvt_pk_bf16_f32 v38, v108, v109
  v_exp_f32 v111, v111
  v_exp_f32 v80, v80
  v_cvt_pk_bf16_f32 v39, v110, v111
  v_exp_f32 v81, v81
  v_exp_f32 v82, v82
  v_mfma_f32_32x32x16_bf16 v[48:63], v[28:31], v[36:39], v[48:63]
  s_add_u32 m0, s37, 2048
  s_add_u32 s38, s38, s43
  buffer_load_dwordx4 v112, s[12:15], s39 offen lds
  s_add_u32 s39, s39, s43
  v_cvt_pk_bf16_f32 v32, v80, v81
  v_exp_f32 v83, v83
  s_waitcnt lgkmcnt(0)
  ds_read_b128 v[8:11], v42 offset:4096
  s_mov_b64 exec, s[22:23]
  ds_read_b128 v[24:27], v43 offset:3072
  ds_read_b128 v[28:31], v43 offset:3584
  s_mov_b64 exec, -1
  v_exp_f32 v84, v84
  v_cvt_pk_bf16_f32 v33, v82, v83
  v_exp_f32 v85, v85
  v_exp_f32 v86, v86
  v_cvt_pk_bf16_f32 v34, v84, v85
  v_mfma_f32_32x32x16_bf16 v[96:111], v[12:15], v[4:7], v[64:79]
  v_exp_f32 v87, v87
  v_exp_f32 v88, v88
  v_cvt_pk_bf16_f32 v35, v86, v87
  v_exp_f32 v89, v89
  v_exp_f32 v90, v90
  v_mfma_f32_32x32x16_bf16 v[48:63], v[16:19], v[32:35], v[48:63]
  s_nop 0
  v_cvt_pk_bf16_f32 v36, v88, v89
  v_exp_f32 v91, v91
  v_exp_f32 v92, v92
  v_cvt_pk_bf16_f32 v37, v90, v91
  v_exp_f32 v93, v93
  v_exp_f32 v94, v94
  v_cvt_pk_bf16_f32 v38, v92, v93
  v_exp_f32 v95, v95
  v_exp_f32 v96, v96
  v_cvt_pk_bf16_f32 v39, v94, v95
  v_exp_f32 v97, v97
  v_exp_f32 v98, v98
  v_mfma_f32_32x32x16_bf16 v[48:63], v[20:23], v[36:39], v[48:63]
  buffer_load_dwordx2 v[148:149], v122, s[4:7], s40 offen offset:32 sc1
  buffer_load_dwordx2 v[150:151], v122, s[4:7], s40 offen offset:48 sc1
  v_cvt_pk_bf16_f32 v32, v96, v97
  v_exp_f32 v99, v99
  s_waitcnt lgkmcnt(0)
  ds_read_b128 v[12:15], v42 offset:5120
  s_mov_b64 exec, s[22:23]
  ds_read_b128 v[16:19], v43 offset:4096
  ds_read_b128 v[20:23], v43 offset:4608
  s_mov_b64 exec, -1
  v_exp_f32 v100, v100
  v_cvt_pk_bf16_f32 v33, v98, v99
  v_exp_f32 v101, v101
  v_exp_f32 v102, v102
  v_cvt_pk_bf16_f32 v34, v100, v101
  v_mfma_f32_32x32x16_bf16 v[80:95], v[8:11], v[4:7], v[64:79]
  v_exp_f32 v103, v103
  v_exp_f32 v104, v104
  v_cvt_pk_bf16_f32 v35, v102, v103
  v_exp_f32 v105, v105
  v_exp_f32 v106, v106
  v_mfma_f32_32x32x16_bf16 v[48:63], v[24:27], v[32:35], v[48:63]
  s_nop 0
  v_cvt_pk_bf16_f32 v36, v104, v105
  v_exp_f32 v107, v107
  v_exp_f32 v108, v108
  v_cvt_pk_bf16_f32 v37, v106, v107
  v_exp_f32 v109, v109
  v_exp_f32 v110, v110
  v_cvt_pk_bf16_f32 v38, v108, v109
  v_exp_f32 v111, v111
  v_exp_f32 v80, v80
  v_cvt_pk_bf16_f32 v39, v110, v111
  v_exp_f32 v81, v81
  v_exp_f32 v82, v82
  v_mfma_f32_32x32x16_bf16 v[48:63], v[28:31], v[36:39], v[48:63]
  s_add_u32 m0, s37, 1024
  s_nop 0
  buffer_load_dwordx4 v112, s[8:11], s38 offen lds
  v_cvt_pk_bf16_f32 v32, v80, v81
  v_exp_f32 v83, v83
  s_waitcnt lgkmcnt(0)
  ds_read_b128 v[8:11], v42 offset:6144
  s_mov_b64 exec, s[22:23]
  ds_read_b128 v[24:27], v43 offset:5120
  ds_read_b128 v[28:31], v43 offset:5632
  s_mov_b64 exec, -1
  v_exp_f32 v84, v84
  v_cvt_pk_bf16_f32 v33, v82, v83
  v_exp_f32 v85, v85
  v_exp_f32 v86, v86
  v_cvt_pk_bf16_f32 v34, v84, v85
  v_mfma_f32_32x32x16_bf16 v[96:111], v[12:15], v[4:7], v[64:79]
  v_exp_f32 v87, v87
  v_exp_f32 v88, v88
  v_cvt_pk_bf16_f32 v35, v86, v87
  v_exp_f32 v89, v89
  v_exp_f32 v90, v90
  v_mfma_f32_32x32x16_bf16 v[48:63], v[16:19], v[32:35], v[48:63]
  s_nop 0
  v_cvt_pk_bf16_f32 v36, v88, v89
  v_exp_f32 v91, v91
  v_exp_f32 v92, v92
  v_cvt_pk_bf16_f32 v37, v90, v91
  v_exp_f32 v93, v93
  v_exp_f32 v94, v94
  v_cvt_pk_bf16_f32 v38, v92, v93
  v_exp_f32 v95, v95
  v_exp_f32 v96, v96
  v_cvt_pk_bf16_f32 v39, v94, v95
  v_exp_f32 v97, v97
  v_exp_f32 v98, v98
  v_mfma_f32_32x32x16_bf16 v[48:63], v[20:23], v[36:39], v[48:63]
  buffer_load_dwordx2 v[152:153], v122, s[4:7], s40 offen offset:64 sc1
  buffer_load_dwordx2 v[154:155], v122, s[4:7], s40 offen offset:80 sc1
  v_cvt_pk_bf16_f32 v32, v96, v97
  v_exp_f32 v99, v99
  s_waitcnt lgkmcnt(0)
  ds_read_b128 v[12:15], v42 offset:7168
  s_mov_b64 exec, s[22:23]
  ds_read_b128 v[16:19], v43 offset:6144
  ds_read_b128 v[20:23], v43 offset:6656
  s_mov_b64 exec, -1
  v_exp_f32 v100, v100
  v_cvt_pk_bf16_f32 v33, v98, v99
  v_exp_f32 v101, v101
  v_exp_f32 v102, v102
  v_cvt_pk_bf16_f32 v34, v100, v101
  v_mfma_f32_32x32x16_bf16 v[80:95], v[8:11], v[4:7], v[64:79]
  v_exp_f32 v103, v103
  v_exp_f32 v104, v104
  v_cvt_pk_bf16_f32 v35, v102, v103
  v_exp_f32 v105, v105
  v_exp_f32 v106, v106
  v_mfma_f32_32x32x16_bf16 v[48:63], v[24:27], v[32:35], v[48:63]
  s_nop 0
  v_cvt_pk_bf16_f32 v36, v104, v105
  v_exp_f32 v107, v107
  v_exp_f32 v108, v108
  v_cvt_pk_bf16_f32 v37, v106, v107
  v_exp_f32 v109, v109
  v_exp_f32 v110, v110
  v_cvt_pk_bf16_f32 v38, v108, v109
  v_exp_f32 v111, v111
  v_exp_f32 v80, v80
  v_cvt_pk_bf16_f32 v39, v110, v111
  v_exp_f32 v81, v81
  v_exp_f32 v82, v82
  v_mfma_f32_32x32x16_bf16 v[48:63], v[28:31], v[36:39], v[48:63]
  s_add_u32 m0, s37, 3072
  s_add_u32 s38, s38, s43
  buffer_load_dwordx4 v112, s[12:15], s39 offen lds
  s_add_u32 s39, s39, s43
  v_cvt_pk_bf16_f32 v32, v80, v81
  v_exp_f32 v83, v83
  s_waitcnt lgkmcnt(0)
  ds_read_b128 v[8:11], v42 offset:8192
  s_mov_b64 exec, s[22:23]
  ds_read_b128 v[24:27], v43 offset:7168
  ds_read_b128 v[28:31], v43 offset:7680
  s_mov_b64 exec, -1
  v_exp_f32 v84, v84
  v_cvt_pk_bf16_f32 v33, v82, v83
  v_exp_f32 v85, v85
  v_exp_f32 v86, v86
  v_cvt_pk_bf16_f32 v34, v84, v85
  v_mfma_f32_32x32x16_bf16 v[96:111], v[12:15], v[4:7], v[64:79]
  v_exp_f32 v87, v87
  v_exp_f32 v88, v88
  v_cvt_pk_bf16_f32 v35, v86, v87
  v_exp_f32 v89, v89
  v_exp_f32 v90, v90
  v_mfma_f32_32x32x16_bf16 v[48:63], v[16:19], v[32:35], v[48:63]
  s_nop 0
  v_cvt_pk_bf16_f32 v36, v88, v89
  v_exp_f32 v91, v91
  v_exp_f32 v92, v92
  v_cvt_pk_bf16_f32 v37, v90, v91
  v_exp_f32 v93, v93
  v_exp_f32 v94, v94
  v_cvt_pk_bf16_f32 v38, v92, v93
  v_exp_f32 v95, v95
  v_exp_f32 v96, v96
  v_cvt_pk_bf16_f32 v39, v94, v95
  v_exp_f32 v97, v97
  v_exp_f32 v98, v98
  v_mfma_f32_32x32x16_bf16 v[48:63], v[20:23], v[36:39], v[48:63]
  buffer_load_dwordx2 v[156:157], v122, s[4:7], s40 offen offset:96 sc1
  buffer_load_dwordx2 v[158:159], v122, s[4:7], s40 offen offset:112 sc1
  v_cvt_pk_bf16_f32 v32, v96, v97
  v_exp_f32 v99, v99
  s_waitcnt lgkmcnt(0)
  ds_read_b128 v[12:15], v42 offset:9216
  s_mov_b64 exec, s[22:23]
  ds_read_b128 v[16:19], v43 offset:8192
  ds_read_b128 v[20:23], v43 offset:8704
  s_mov_b64 exec, -1
  v_exp_f32 v100, v100
  v_cvt_pk_bf16_f32 v33, v98, v99
  v_exp_f32 v101, v101
  v_exp_f32 v102, v102
  v_cvt_pk_bf16_f32 v34, v100, v101
  v_mfma_f32_32x32x16_bf16 v[80:95], v[8:11], v[4:7], v[64:79]
  v_exp_f32 v103, v103
  v_exp_f32 v104, v104
  v_cvt_pk_bf16_f32 v35, v102, v103
  v_exp_f32 v105, v105
  v_exp_f32 v106, v106
  v_mfma_f32_32x32x16_bf16 v[48:63], v[24:27], v[32:35], v[48:63]
  s_nop 0
  v_cvt_pk_bf16_f32 v36, v104, v105
  v_exp_f32 v107, v107
  v_exp_f32 v108, v108
  v_cvt_pk_bf16_f32 v37, v106, v107
  v_exp_f32 v109, v109
  v_exp_f32 v110, v110
  v_cvt_pk_bf16_f32 v38, v108, v109
  v_exp_f32 v111, v111
  s_branch adaLN_cond__grouped_kv_mqa__glu_gated_swiglu__prompt_kernel_lnext
adaLN_cond__grouped_kv_mqa__glu_gated_swiglu__prompt_kernel_nb1:
  s_sub_u32 s21, s28, s20
  s_cmp_eq_u32 s21, 1
  s_cbranch_scc1 adaLN_cond__grouped_kv_mqa__glu_gated_swiglu__prompt_kernel_bump
  s_cmp_eq_u32 s21, 3
  s_cbranch_scc1 adaLN_cond__grouped_kv_mqa__glu_gated_swiglu__prompt_kernel_pka
  s_cmp_eq_u32 s28, 5
  s_cbranch_scc1 adaLN_cond__grouped_kv_mqa__glu_gated_swiglu__prompt_kernel_fl1
  s_cmp_eq_u32 s28, 6
  s_cbranch_scc1 adaLN_cond__grouped_kv_mqa__glu_gated_swiglu__prompt_kernel_fl2
  s_cmp_eq_u32 s34, 0
  s_cbranch_scc1 adaLN_cond__grouped_kv_mqa__glu_gated_swiglu__prompt_kernel_loop
  s_cmp_eq_u32 s21, 2
  s_cbranch_scc1 adaLN_cond__grouped_kv_mqa__glu_gated_swiglu__prompt_kernel_pkp
  s_branch adaLN_cond__grouped_kv_mqa__glu_gated_swiglu__prompt_kernel_loop
adaLN_cond__grouped_kv_mqa__glu_gated_swiglu__prompt_kernel_pka:
  s_setprio 1
  s_waitcnt vmcnt(0)
  v_readfirstlane_b32 s21, v125
  s_cmp_lg_u32 s3, 4
  s_cbranch_scc1 adaLN_cond__grouped_kv_mqa__glu_gated_swiglu__prompt_kernel_nobump
  s_nop 3
  s_cmp_lg_u32 s21, 255
  s_cbranch_scc1 adaLN_cond__grouped_kv_mqa__glu_gated_swiglu__prompt_kernel_nobump
  s_mov_b32 s21, 360448
  s_mov_b64 exec, 1
  v_lshlrev_b32 v112, 9, v1
  v_mov_b32 v113, s42
  buffer_store_dword v113, v112, s[4:7], s21 offen sc1
  s_mov_b64 exec, -1
adaLN_cond__grouped_kv_mqa__glu_gated_swiglu__prompt_kernel_nobump:
  s_cmp_ge_u32 s2, 192
  s_cbranch_scc1 adaLN_cond__grouped_kv_mqa__glu_gated_swiglu__prompt_kernel_loop
  s_lshl_b32 s21, s31, 3
  s_add_u32 s21, s21, s3
  s_lshl_b32 s21, s21, 2
  s_add_u32 s21, s21, 370688
  s_waitcnt vmcnt(0)
  s_mov_b64 exec, 1
  v_lshlrev_b32 v112, 9, v1
  v_mov_b32 v113, s42
  buffer_store_dword v113, v112, s[4:7], s21 offen sc1
  s_mov_b64 exec, -1
  s_branch adaLN_cond__grouped_kv_mqa__glu_gated_swiglu__prompt_kernel_loop
adaLN_cond__grouped_kv_mqa__glu_gated_swiglu__prompt_kernel_bump:
  s_cmp_lg_u32 s3, 4
  s_cbranch_scc1 adaLN_cond__grouped_kv_mqa__glu_gated_swiglu__prompt_kernel_loop
  s_mov_b32 s76, s56
  s_mov_b32 s77, s57
  s_mov_b32 s78, 256
  s_mov_b32 s79, 0x20000
  s_mov_b64 exec, 1
  v_mov_b32 v124, 0
  v_mov_b32 v125, 1
  buffer_atomic_add v125, v124, s[76:79], 0 offen sc0 sc1
  s_mov_b64 exec, -1
  s_branch adaLN_cond__grouped_kv_mqa__glu_gated_swiglu__prompt_kernel_loop
adaLN_cond__grouped_kv_mqa__glu_gated_swiglu__prompt_kernel_fl1:
  v_min_u32 v115, 55, v1
  v_lshlrev_b32 v115, 2, v115
  v_and_b32 v116, 15, v1
  v_lshlrev_b32 v116, 2, v116
  v_lshlrev_b32 v117, 2, v1
  s_bfe_u32 s50, s2, 0x20001
  s_lshl_b32 s50, s50, 2
  s_lshr_b32 s21, s2, 6
  s_add_u32 s50, s50, s21
  s_mul_i32 s50, s50, 224
  s_add_u32 s50, s50, 370688
  s_lshl_b32 s51, s17, 6
  s_add_u32 s51, s51, 374272
  s_lshl_b32 s52, s17, 8
  s_add_u32 s52, s52, 374784
  buffer_load_dword v112, v115, s[4:7], s50 offen sc1
  buffer_load_dword v113, v116, s[4:7], s51 offen sc1
  buffer_load_dword v114, v117, s[4:7], s52 offen sc1
  s_mov_b32 s30, 0
  s_branch adaLN_cond__grouped_kv_mqa__glu_gated_swiglu__prompt_kernel_loop
adaLN_cond__grouped_kv_mqa__glu_gated_swiglu__prompt_kernel_fl2:
  s_and_b32 s44, s3, 3
  s_lshl_b32 s21, s17, 16
  s_lshl_b32 s29, s44, 13
  s_add_u32 s21, s21, s29
  s_add_u32 s47, s21, 2097152
  s_mov_b32 s8, s32
  s_mov_b32 s9, s33
  s_mov_b32 s10, 0x200000
  s_mov_b32 s11, 0x20000
  s_lshl_b32 s45, s17, 2
  s_add_u32 s45, s45, s44
  v_and_b32 v118, 31, v1
  v_lshlrev_b32 v119, 4, v3
  v_lshlrev_b32 v118, 10, v118
  v_lshl_add_u32 v118, v3, 3, v118
  s_lshl_b32 s46, s16, 1
  s_add_u32 s46, s46, s20
  s_lshl_b32 s46, s46, 15
  s_lshl_b32 s29, s45, 5
  s_add_u32 s46, s46, s29
  s_lshl_b32 s29, s45, 6
  s_add_u32 s48, s29, 4096
  s_add_u32 s49, s29, 8192
  s_bfe_u32 s40, s2, 0x20001
  s_lshl_b32 s40, s40, 2
  s_lshr_b32 s21, s2, 6
  s_add_u32 s40, s40, s21
  s_lshl_b32 s40, s40, 3
  s_add_u32 s40, s40, s17
  s_lshl_b32 s40, s40, 3
  s_add_u32 s40, s40, s3
  s_mul_i32 s40, s40, 3584
  s_add_u32 s40, s40, 3145728
  s_lshl_b32 s41, s17, 2
  s_add_u32 s41, s41, s21
  s_lshl_b32 s41, s41, 3
  s_add_u32 s41, s41, s3
  s_mul_i32 s41, s41, 7168
  s_add_u32 s41, s41, 7340032
  v_min_u32 v120, 27, v1
  v_lshlrev_b32 v120, 7, v120
  v_lshlrev_b32 v121, 5, v115
  s_waitcnt vmcnt(0)
  v_xor_b32 v112, s42, v112
  v_xor_b32 v113, s42, v113
  v_xor_b32 v114, s42, v114
  v_or3_b32 v112, v112, v113, v114
  v_cmp_ne_u32 vcc, 0, v112
  s_add_u32 s30, s30, 1
  s_nop 1
  s_cbranch_vccz adaLN_cond__grouped_kv_mqa__glu_gated_swiglu__prompt_kernel_fl3
  s_mov_b32 s53, 1
  buffer_load_dword v112, v115, s[4:7], s50 offen sc1
  buffer_load_dword v113, v116, s[4:7], s51 offen sc1
  buffer_load_dword v114, v117, s[4:7], s52 offen sc1
  s_waitcnt vmcnt(0)
  v_xor_b32 v112, s42, v112
  v_xor_b32 v113, s42, v113
  v_xor_b32 v114, s42, v114
  v_or3_b32 v112, v112, v113, v114
  v_cmp_ne_u32 vcc, 0, v112
  s_add_u32 s30, s30, 1
  s_nop 1
  s_cbranch_vccnz adaLN_cond__grouped_kv_mqa__glu_gated_swiglu__prompt_kernel_loop
adaLN_cond__grouped_kv_mqa__glu_gated_swiglu__prompt_kernel_fl3:
  s_mov_b32 s53, 0
  v_exp_f32 v80, v80
  v_cvt_pk_bf16_f32 v39, v110, v111
  v_exp_f32 v81, v81
  v_exp_f32 v82, v82
  v_mfma_f32_32x32x16_bf16 v[48:63], v[28:31], v[36:39], v[48:63]
  buffer_load_dword v122, v120, s[4:7], s40 offen sc1
  v_cvt_pk_bf16_f32 v32, v80, v81
  v_exp_f32 v83, v83
  s_waitcnt lgkmcnt(0)
  ds_read_b128 v[8:11], v42 offset:2048
  s_mov_b64 exec, s[22:23]
  ds_read_b128 v[24:27], v43 offset:1024
  ds_read_b128 v[28:31], v43 offset:1536
  s_mov_b64 exec, -1
  v_exp_f32 v84, v84
  v_cvt_pk_bf16_f32 v33, v82, v83
  v_exp_f32 v85, v85
  v_exp_f32 v86, v86
  v_cvt_pk_bf16_f32 v34, v84, v85
  v_mfma_f32_32x32x16_bf16 v[96:111], v[12:15], v[4:7], v[64:79]
  buffer_load_dwordx4 v[128:131], v2, s[4:7], s47 offen offset:0 sc1
  v_exp_f32 v87, v87
  v_exp_f32 v88, v88
  v_cvt_pk_bf16_f32 v35, v86, v87
  v_exp_f32 v89, v89
  v_exp_f32 v90, v90
  v_mfma_f32_32x32x16_bf16 v[48:63], v[16:19], v[32:35], v[48:63]
  buffer_load_dwordx4 v[132:135], v2, s[4:7], s47 offen offset:1024 sc1
  v_cvt_pk_bf16_f32 v36, v88, v89
  v_exp_f32 v91, v91
  v_exp_f32 v92, v92
  v_cvt_pk_bf16_f32 v37, v90, v91
  v_exp_f32 v93, v93
  v_exp_f32 v94, v94
  v_cvt_pk_bf16_f32 v38, v92, v93
  v_exp_f32 v95, v95
  v_exp_f32 v96, v96
  v_cvt_pk_bf16_f32 v39, v94, v95
  v_exp_f32 v97, v97
  v_exp_f32 v98, v98
  v_mfma_f32_32x32x16_bf16 v[48:63], v[20:23], v[36:39], v[48:63]
  buffer_load_dwordx4 v[136:139], v2, s[4:7], s47 offen offset:2048 sc1
  v_cvt_pk_bf16_f32 v32, v96, v97
  v_exp_f32 v99, v99
  s_waitcnt lgkmcnt(0)
  ds_read_b128 v[12:15], v42 offset:3072
  s_mov_b64 exec, s[22:23]
  ds_read_b128 v[16:19], v43 offset:2048
  ds_read_b128 v[20:23], v43 offset:2560
  s_mov_b64 exec, -1
  v_exp_f32 v100, v100
  v_cvt_pk_bf16_f32 v33, v98, v99
  v_exp_f32 v101, v101
  v_exp_f32 v102, v102
  v_cvt_pk_bf16_f32 v34, v100, v101
  v_mfma_f32_32x32x16_bf16 v[80:95], v[8:11], v[4:7], v[64:79]
  buffer_load_dwordx4 v[140:143], v2, s[4:7], s47 offen offset:3072 sc1
  s_add_u32 s47, s47, 4096
  v_exp_f32 v103, v103
  v_exp_f32 v104, v104
  v_cvt_pk_bf16_f32 v35, v102, v103
  v_exp_f32 v105, v105
  v_exp_f32 v106, v106
  v_mfma_f32_32x32x16_bf16 v[48:63], v[24:27], v[32:35], v[48:63]
  buffer_load_dwordx4 v[144:147], v2, s[4:7], s47 offen offset:0 sc1
  v_cvt_pk_bf16_f32 v36, v104, v105
  v_exp_f32 v107, v107
  v_exp_f32 v108, v108
  v_cvt_pk_bf16_f32 v37, v106, v107
  v_exp_f32 v109, v109
  v_exp_f32 v110, v110
  v_cvt_pk_bf16_f32 v38, v108, v109
  v_exp_f32 v111, v111
  v_exp_f32 v80, v80
  v_cvt_pk_bf16_f32 v39, v110, v111
  v_exp_f32 v81, v81
  v_exp_f32 v82, v82
  v_mfma_f32_32x32x16_bf16 v[48:63], v[28:31], v[36:39], v[48:63]
  buffer_load_dwordx4 v[148:151], v2, s[4:7], s47 offen offset:1024 sc1
  v_cvt_pk_bf16_f32 v32, v80, v81
  v_exp_f32 v83, v83
  s_waitcnt lgkmcnt(0)
  ds_read_b128 v[8:11], v42 offset:4096
  s_mov_b64 exec, s[22:23]
  ds_read_b128 v[24:27], v43 offset:3072
  ds_read_b128 v[28:31], v43 offset:3584
  s_mov_b64 exec, -1
  v_exp_f32 v84, v84
  v_cvt_pk_bf16_f32 v33, v82, v83
  v_exp_f32 v85, v85
  v_exp_f32 v86, v86
  v_cvt_pk_bf16_f32 v34, v84, v85
  v_mfma_f32_32x32x16_bf16 v[96:111], v[12:15], v[4:7], v[64:79]
  buffer_load_dwordx4 v[152:155], v2, s[4:7], s47 offen offset:2048 sc1
  v_exp_f32 v87, v87
  v_exp_f32 v88, v88
  v_cvt_pk_bf16_f32 v35, v86, v87
  v_exp_f32 v89, v89
  v_exp_f32 v90, v90
  v_mfma_f32_32x32x16_bf16 v[48:63], v[16:19], v[32:35], v[48:63]
  buffer_load_dwordx4 v[156:159], v2, s[4:7], s47 offen offset:3072 sc1
  s_add_u32 s47, s47, 28672
  v_cvt_pk_bf16_f32 v36, v88, v89
  v_exp_f32 v91, v91
  v_exp_f32 v92, v92
  v_cvt_pk_bf16_f32 v37, v90, v91
  v_exp_f32 v93, v93
  v_exp_f32 v94, v94
  v_cvt_pk_bf16_f32 v38, v92, v93
  v_exp_f32 v95, v95
  v_exp_f32 v96, v96
  v_cvt_pk_bf16_f32 v39, v94, v95
  v_exp_f32 v97, v97
  v_exp_f32 v98, v98
  v_mfma_f32_32x32x16_bf16 v[48:63], v[20:23], v[36:39], v[48:63]
  buffer_load_dwordx4 v[160:163], v2, s[4:7], s47 offen offset:0 sc1
  v_cvt_pk_bf16_f32 v32, v96, v97
  v_exp_f32 v99, v99
  s_waitcnt lgkmcnt(0)
  ds_read_b128 v[12:15], v42 offset:5120
  s_mov_b64 exec, s[22:23]
  ds_read_b128 v[16:19], v43 offset:4096
  ds_read_b128 v[20:23], v43 offset:4608
  s_mov_b64 exec, -1
  v_exp_f32 v100, v100
  v_cvt_pk_bf16_f32 v33, v98, v99
  v_exp_f32 v101, v101
  v_exp_f32 v102, v102
  v_cvt_pk_bf16_f32 v34, v100, v101
  v_mfma_f32_32x32x16_bf16 v[80:95], v[8:11], v[4:7], v[64:79]
  buffer_load_dwordx4 v[164:167], v2, s[4:7], s47 offen offset:1024 sc1
  v_exp_f32 v103, v103
  v_exp_f32 v104, v104
  v_cvt_pk_bf16_f32 v35, v102, v103
  v_exp_f32 v105, v105
  v_exp_f32 v106, v106
  v_mfma_f32_32x32x16_bf16 v[48:63], v[24:27], v[32:35], v[48:63]
  buffer_load_dwordx4 v[168:171], v2, s[4:7], s47 offen offset:2048 sc1
  v_cvt_pk_bf16_f32 v36, v104, v105
  v_exp_f32 v107, v107
  v_exp_f32 v108, v108
  v_cvt_pk_bf16_f32 v37, v106, v107
  v_exp_f32 v109, v109
  v_exp_f32 v110, v110
  v_cvt_pk_bf16_f32 v38, v108, v109
  v_exp_f32 v111, v111
  v_exp_f32 v80, v80
  v_cvt_pk_bf16_f32 v39, v110, v111
  v_exp_f32 v81, v81
  v_exp_f32 v82, v82
  v_mfma_f32_32x32x16_bf16 v[48:63], v[28:31], v[36:39], v[48:63]
  buffer_load_dwordx4 v[172:175], v2, s[4:7], s47 offen offset:3072 sc1
  s_add_u32 s47, s47, 4096
  v_cvt_pk_bf16_f32 v32, v80, v81
  v_exp_f32 v83, v83
  s_waitcnt lgkmcnt(0)
  ds_read_b128 v[8:11], v42 offset:6144
  s_mov_b64 exec, s[22:23]
  ds_read_b128 v[24:27], v43 offset:5120
  ds_read_b128 v[28:31], v43 offset:5632
  s_mov_b64 exec, -1
  v_exp_f32 v84, v84
  v_cvt_pk_bf16_f32 v33, v82, v83
  v_exp_f32 v85, v85
  v_exp_f32 v86, v86
  v_cvt_pk_bf16_f32 v34, v84, v85
  v_mfma_f32_32x32x16_bf16 v[96:111], v[12:15], v[4:7], v[64:79]
  buffer_load_dwordx4 v[176:179], v2, s[4:7], s47 offen offset:0 sc1
  v_exp_f32 v87, v87
  v_exp_f32 v88, v88
  v_cvt_pk_bf16_f32 v35, v86, v87
  v_exp_f32 v89, v89
  v_exp_f32 v90, v90
  v_mfma_f32_32x32x16_bf16 v[48:63], v[16:19], v[32:35], v[48:63]
  buffer_load_dwordx4 v[180:183], v2, s[4:7], s47 offen offset:1024 sc1
  v_cvt_pk_bf16_f32 v36, v88, v89
  v_exp_f32 v91, v91
  v_exp_f32 v92, v92
  v_cvt_pk_bf16_f32 v37, v90, v91
  v_exp_f32 v93, v93
  v_exp_f32 v94, v94
  v_cvt_pk_bf16_f32 v38, v92, v93
  v_exp_f32 v95, v95
  v_exp_f32 v96, v96
  v_cvt_pk_bf16_f32 v39, v94, v95
  v_exp_f32 v97, v97
  v_exp_f32 v98, v98
  v_mfma_f32_32x32x16_bf16 v[48:63], v[20:23], v[36:39], v[48:63]
  buffer_load_dwordx4 v[184:187], v2, s[4:7], s47 offen offset:2048 sc1
  v_cvt_pk_bf16_f32 v32, v96, v97
  v_exp_f32 v99, v99
  s_waitcnt lgkmcnt(0)
  ds_read_b128 v[12:15], v42 offset:7168
  s_mov_b64 exec, s[22:23]
  ds_read_b128 v[16:19], v43 offset:6144
  ds_read_b128 v[20:23], v43 offset:6656
  s_mov_b64 exec, -1
  v_exp_f32 v100, v100
  v_cvt_pk_bf16_f32 v33, v98, v99
  v_exp_f32 v101, v101
  v_exp_f32 v102, v102
  v_cvt_pk_bf16_f32 v34, v100, v101
  v_mfma_f32_32x32x16_bf16 v[80:95], v[8:11], v[4:7], v[64:79]
  buffer_load_dwordx4 v[188:191], v2, s[4:7], s47 offen offset:3072 sc1
  s_add_u32 s47, s47, 28672
  v_exp_f32 v103, v103
  v_exp_f32 v104, v104
  v_cvt_pk_bf16_f32 v35, v102, v103
  v_exp_f32 v105, v105
  v_exp_f32 v106, v106
  v_mfma_f32_32x32x16_bf16 v[48:63], v[24:27], v[32:35], v[48:63]
  buffer_load_dwordx2 v[192:193], v118, s[8:11], s46 offen offset:0
  v_cvt_pk_bf16_f32 v36, v104, v105
  v_exp_f32 v107, v107
  v_exp_f32 v108, v108
  v_cvt_pk_bf16_f32 v37, v106, v107
  v_exp_f32 v109, v109
  v_exp_f32 v110, v110
  v_cvt_pk_bf16_f32 v38, v108, v109
  v_exp_f32 v111, v111
  v_exp_f32 v80, v80
  v_cvt_pk_bf16_f32 v39, v110, v111
  v_exp_f32 v81, v81
  v_exp_f32 v82, v82
  v_mfma_f32_32x32x16_bf16 v[48:63], v[28:31], v[36:39], v[48:63]
  buffer_load_dwordx4 v[196:199], v119, s[4:7], s48 offen offset:0 sc1
  v_cvt_pk_bf16_f32 v32, v80, v81
  v_exp_f32 v83, v83
  s_waitcnt lgkmcnt(0)
  ds_read_b128 v[8:11], v42 offset:8192
  s_mov_b64 exec, s[22:23]
  ds_read_b128 v[24:27], v43 offset:7168
  ds_read_b128 v[28:31], v43 offset:7680
  s_mov_b64 exec, -1
  v_exp_f32 v84, v84
  v_cvt_pk_bf16_f32 v33, v82, v83
  v_exp_f32 v85, v85
  v_exp_f32 v86, v86
  v_cvt_pk_bf16_f32 v34, v84, v85
  v_mfma_f32_32x32x16_bf16 v[96:111], v[12:15], v[4:7], v[64:79]
  buffer_load_dwordx4 v[204:207], v119, s[4:7], s49 offen offset:0 sc1
  v_exp_f32 v87, v87
  v_exp_f32 v88, v88
  v_cvt_pk_bf16_f32 v35, v86, v87
  v_exp_f32 v89, v89
  v_exp_f32 v90, v90
  v_mfma_f32_32x32x16_bf16 v[48:63], v[16:19], v[32:35], v[48:63]
  buffer_load_dwordx2 v[194:195], v118, s[8:11], s46 offen offset:16
  v_cvt_pk_bf16_f32 v36, v88, v89
  v_exp_f32 v91, v91
  v_exp_f32 v92, v92
  v_cvt_pk_bf16_f32 v37, v90, v91
  v_exp_f32 v93, v93
  v_exp_f32 v94, v94
  v_cvt_pk_bf16_f32 v38, v92, v93
  v_exp_f32 v95, v95
  v_exp_f32 v96, v96
  v_cvt_pk_bf16_f32 v39, v94, v95
  v_exp_f32 v97, v97
  v_exp_f32 v98, v98
  v_mfma_f32_32x32x16_bf16 v[48:63], v[20:23], v[36:39], v[48:63]
  buffer_load_dwordx4 v[200:203], v119, s[4:7], s48 offen offset:32 sc1
  v_cvt_pk_bf16_f32 v32, v96, v97
  v_exp_f32 v99, v99
  s_waitcnt lgkmcnt(0)
  ds_read_b128 v[12:15], v42 offset:9216
  s_mov_b64 exec, s[22:23]
  ds_read_b128 v[16:19], v43 offset:8192
  ds_read_b128 v[20:23], v43 offset:8704
  s_mov_b64 exec, -1
  v_exp_f32 v100, v100
  v_cvt_pk_bf16_f32 v33, v98, v99
  v_exp_f32 v101, v101
  v_exp_f32 v102, v102
  v_cvt_pk_bf16_f32 v34, v100, v101
  v_mfma_f32_32x32x16_bf16 v[80:95], v[8:11], v[4:7], v[64:79]
  buffer_load_dwordx4 v[208:211], v119, s[4:7], s49 offen offset:32 sc1
  v_exp_f32 v103, v103
  v_exp_f32 v104, v104
  v_cvt_pk_bf16_f32 v35, v102, v103
  v_exp_f32 v105, v105
  v_exp_f32 v106, v106
  v_mfma_f32_32x32x16_bf16 v[48:63], v[24:27], v[32:35], v[48:63]
  v_cvt_pk_bf16_f32 v36, v104, v105
  v_exp_f32 v107, v107
  v_exp_f32 v108, v108
  v_cvt_pk_bf16_f32 v37, v106, v107
  v_exp_f32 v109, v109
  v_exp_f32 v110, v110
  v_cvt_pk_bf16_f32 v38, v108, v109
  v_exp_f32 v111, v111
  s_branch adaLN_cond__grouped_kv_mqa__glu_gated_swiglu__prompt_kernel_lnext
adaLN_cond__grouped_kv_mqa__glu_gated_swiglu__prompt_kernel_pkp:
  v_bfe_u32 v113, v1, 4, 1
  v_mul_u32_u24 v112, 2048, v113
  v_lshrrev_b32 v113, 5, v1
  v_lshl_add_u32 v112, v113, 7, v112
  v_and_b32 v113, 15, v1
  v_lshl_add_u32 v112, v113, 3, v112
  v_add_u32 v112, s37, v112
  v_and_b32 v113, 31, v1
  s_waitcnt vmcnt(0)
  ds_read_b64_tr_b16 v[128:129], v112 offset:0
  ds_read_b64_tr_b16 v[130:131], v112 offset:256
  ds_read_b64_tr_b16 v[132:133], v112 offset:512
  ds_read_b64_tr_b16 v[134:135], v112 offset:768
  ds_read_b64_tr_b16 v[136:137], v112 offset:1024
  ds_read_b64_tr_b16 v[138:139], v112 offset:1280
  ds_read_b64_tr_b16 v[140:141], v112 offset:1536
  ds_read_b64_tr_b16 v[142:143], v112 offset:1792
  s_waitcnt lgkmcnt(0)
  buffer_store_dwordx4 v[128:131], v2, s[4:7], s35 offen offset:0 sc1
  buffer_store_dwordx4 v[132:135], v2, s[4:7], s35 offen offset:1024 sc1
  buffer_store_dwordx4 v[136:139], v2, s[4:7], s35 offen offset:2048 sc1
  buffer_store_dwordx4 v[140:143], v2, s[4:7], s35 offen offset:3072 sc1
  s_cmp_lg_u32 s34, 1
  s_cbranch_scc1 adaLN_cond__grouped_kv_mqa__glu_gated_swiglu__prompt_kernel_loop
  v_mfma_f32_32x32x16_bf16 v[160:175], v[128:131], v[144:147], 0
  v_mfma_f32_32x32x16_bf16 v[160:175], v[132:135], v[148:151], v[160:175]
  v_mfma_f32_32x32x16_bf16 v[160:175], v[136:139], v[152:155], v[160:175]
  v_mfma_f32_32x32x16_bf16 v[160:175], v[140:143], v[156:159], v[160:175]
  v_lshlrev_b32 v114, 6, v3
  v_lshl_add_u32 v114, v113, 7, v114
  v_mov_b32 v115, 0x40000000
  v_cmp_gt_u32 vcc, 2, v113
  s_lshl_b32 s21, s36, 11
  s_lshl_b32 s29, s3, 8
  v_cndmask_b32 v114, v115, v114, vcc
  s_add_u32 s21, s21, s29
  s_add_u32 s21, s21, 524288
  s_nop 4
  buffer_store_dwordx4 v[160:163], v114, s[4:7], s21 offen offset:0 sc1
  buffer_store_dwordx4 v[164:167], v114, s[4:7], s21 offen offset:16 sc1
  buffer_store_dwordx4 v[168:171], v114, s[4:7], s21 offen offset:32 sc1
  buffer_store_dwordx4 v[172:175], v114, s[4:7], s21 offen offset:48 sc1
  s_branch adaLN_cond__grouped_kv_mqa__glu_gated_swiglu__prompt_kernel_loop
adaLN_cond__grouped_kv_mqa__glu_gated_swiglu__prompt_kernel_nobar:
  s_cmp_lt_u32 s27, 7
  s_cbranch_scc1 adaLN_cond__grouped_kv_mqa__glu_gated_swiglu__prompt_kernel_loop
  s_setprio 0
  s_cmp_lt_u32 s27, 8
  s_cbranch_scc1 adaLN_cond__grouped_kv_mqa__glu_gated_swiglu__prompt_kernel_loop
adaLN_cond__grouped_kv_mqa__glu_gated_swiglu__prompt_kernel_lend:
  v_cvt_pk_bf16_f32 v39, v110, v111
  s_nop 1
  v_mfma_f32_32x32x16_bf16 v[48:63], v[28:31], v[36:39], v[48:63]
  s_waitcnt lgkmcnt(0)
  s_nop 7
  s_nop 2
  v_max3_f32 v40, abs(v48), abs(v49), abs(v50)
  v_max3_f32 v41, abs(v51), abs(v52), abs(v53)
  v_max3_f32 v40, abs(v54), abs(v55), v40
  v_max3_f32 v40, v40, v41, v56
  v_add_f32 v41, v48, v49
  v_add_f32 v42, v50, v51
  v_add_f32 v43, v52, v53
  v_add_f32 v45, v54, v55
  v_add_f32 v41, v41, v42
  v_add_f32 v43, v43, v45
  v_add_f32 v41, v41, v43
  v_add_f32 v41, v41, v56
  v_fma_f32 v40, v41, 0, v40
  s_mov_b32 s29, 0x7b800000
  v_rcp_f32 v45, v56
  v_cmp_nle_f32 vcc, v40, s29
  s_cmp_lg_u32 s26, 0
  s_cbranch_scc1 adaLN_cond__grouped_kv_mqa__glu_gated_swiglu__prompt_kernel_fin
  s_nop 4
  s_cbranch_vccz adaLN_cond__grouped_kv_mqa__glu_gated_swiglu__prompt_kernel_fin
  s_mov_b32 s26, 16
  s_mov_b32 s24, 64
  s_mov_b32 s25, 0
  s_branch adaLN_cond__grouped_kv_mqa__glu_gated_swiglu__prompt_kernel_restart
adaLN_cond__grouped_kv_mqa__glu_gated_swiglu__prompt_kernel_fin:
  v_mul_f32 v48, v48, v45
  v_mul_f32 v49, v49, v45
  v_mul_f32 v50, v50, v45
  v_mul_f32 v51, v51, v45
  v_mul_f32 v52, v52, v45
  v_mul_f32 v53, v53, v45
  v_mul_f32 v54, v54, v45
  v_mul_f32 v55, v55, v45
  v_cvt_pk_bf16_f32 v32, v48, v49
  v_cvt_pk_bf16_f32 v33, v50, v51
  v_cvt_pk_bf16_f32 v34, v52, v53
  v_cvt_pk_bf16_f32 v35, v54, v55
  s_lshl_b32 s21, s16, 1
  s_and_b32 s29, s3, 1
  s_add_u32 s21, s21, s29
  s_lshl_b32 s21, s21, 3
  s_add_u32 s21, s21, s17
  s_lshl_b32 s21, s21, 2
  s_and_b32 s29, s3, 2
  s_add_u32 s21, s21, s29
  s_add_u32 s21, s21, s20
  s_lshl_b32 s21, s21, 10
  s_add_u32 s21, s21, 11534336
  buffer_store_dwordx4 v[32:35], v2, s[4:7], s21 offen sc1
  s_cmp_eq_u32 s53, 0
  s_cbranch_scc1 adaLN_cond__grouped_kv_mqa__glu_gated_swiglu__prompt_kernel_nolate
adaLN_cond__grouped_kv_mqa__glu_gated_swiglu__prompt_kernel_late:
  buffer_load_dword v112, v115, s[4:7], s50 offen sc1
  buffer_load_dword v113, v116, s[4:7], s51 offen sc1
  buffer_load_dword v114, v117, s[4:7], s52 offen sc1
  s_waitcnt vmcnt(0)
  v_xor_b32 v112, s42, v112
  v_xor_b32 v113, s42, v113
  v_xor_b32 v114, s42, v114
  v_or3_b32 v112, v112, v113, v114
  v_cmp_ne_u32 vcc, 0, v112
  s_add_u32 s30, s30, 1
  s_nop 1
  s_cbranch_vccz adaLN_cond__grouped_kv_mqa__glu_gated_swiglu__prompt_kernel_late2
  s_sleep 4
  s_cmp_lt_u32 s30, 0x20000
  s_cbranch_scc1 adaLN_cond__grouped_kv_mqa__glu_gated_swiglu__prompt_kernel_late
adaLN_cond__grouped_kv_mqa__glu_gated_swiglu__prompt_kernel_late2:
  buffer_load_dword v122, v120, s[4:7], s40 offen sc1
  buffer_load_dwordx4 v[128:131], v2, s[4:7], s47 offen offset:0 sc1
  buffer_load_dwordx4 v[132:135], v2, s[4:7], s47 offen offset:1024 sc1
  buffer_load_dwordx4 v[136:139], v2, s[4:7], s47 offen offset:2048 sc1
  buffer_load_dwordx4 v[140:143], v2, s[4:7], s47 offen offset:3072 sc1
  s_add_u32 s47, s47, 4096
  buffer_load_dwordx4 v[144:147], v2, s[4:7], s47 offen offset:0 sc1
  buffer_load_dwordx4 v[148:151], v2, s[4:7], s47 offen offset:1024 sc1
  buffer_load_dwordx4 v[152:155], v2, s[4:7], s47 offen offset:2048 sc1
  buffer_load_dwordx4 v[156:159], v2, s[4:7], s47 offen offset:3072 sc1
  s_add_u32 s47, s47, 28672
  buffer_load_dwordx4 v[160:163], v2, s[4:7], s47 offen offset:0 sc1
  buffer_load_dwordx4 v[164:167], v2, s[4:7], s47 offen offset:1024 sc1
  buffer_load_dwordx4 v[168:171], v2, s[4:7], s47 offen offset:2048 sc1
  buffer_load_dwordx4 v[172:175], v2, s[4:7], s47 offen offset:3072 sc1
  s_add_u32 s47, s47, 4096
  buffer_load_dwordx4 v[176:179], v2, s[4:7], s47 offen offset:0 sc1
  buffer_load_dwordx4 v[180:183], v2, s[4:7], s47 offen offset:1024 sc1
  buffer_load_dwordx4 v[184:187], v2, s[4:7], s47 offen offset:2048 sc1
  buffer_load_dwordx4 v[188:191], v2, s[4:7], s47 offen offset:3072 sc1
  s_add_u32 s47, s47, 28672
  buffer_load_dwordx2 v[192:193], v118, s[8:11], s46 offen offset:0
  buffer_load_dwordx4 v[196:199], v119, s[4:7], s48 offen offset:0 sc1
  buffer_load_dwordx4 v[204:207], v119, s[4:7], s49 offen offset:0 sc1
  buffer_load_dwordx2 v[194:195], v118, s[8:11], s46 offen offset:16
  buffer_load_dwordx4 v[200:203], v119, s[4:7], s48 offen offset:32 sc1
  buffer_load_dwordx4 v[208:211], v119, s[4:7], s49 offen offset:32 sc1
adaLN_cond__grouped_kv_mqa__glu_gated_swiglu__prompt_kernel_nolate:
  s_waitcnt vmcnt(0)
  s_barrier
  s_cmp_lg_u32 s3, 0
  s_cbranch_scc1 adaLN_cond__grouped_kv_mqa__glu_gated_swiglu__prompt_kernel_p4n1
  s_lshl_b32 s21, s16, 5
  s_add_u32 s21, s21, s17
  s_lshl_b32 s21, s21, 2
  s_add_u32 s21, s21, 376832
  s_mov_b64 exec, 1
  v_lshlrev_b32 v8, 9, v1
  v_mov_b32 v9, s42
  buffer_store_dword v9, v8, s[4:7], s21 offen sc1
  s_mov_b64 exec, -1
adaLN_cond__grouped_kv_mqa__glu_gated_swiglu__prompt_kernel_p4n1:
  s_and_b32 s18, s3, 3
  s_and_b32 s19, s2, 7
  s_lshl_b32 s19, s19, 2
  s_lshr_b32 s21, s2, 6
  s_add_u32 s19, s19, s21
  s_bfe_u32 s22, s2, 0x30003
  s_lshl_b32 s23, s19, 1
  s_add_u32 s23, s23, s20
  s_lshl_b32 s31, s22, 2
  s_add_u32 s31, s31, s18
  v_and_b32 v4, 31, v1
  v_lshlrev_b32 v5, 4, v3
  v_lshlrev_b32 v6, 10, v4
  v_lshl_add_u32 v6, v3, 3, v6
  s_lshl_b32 s28, s23, 15
  s_lshl_b32 s29, s31, 5
  s_add_u32 s28, s28, s29
  s_lshl_b32 s29, s31, 6
  s_cmp_lg_u32 s3, 0
  s_cbranch_scc1 adaLN_cond__grouped_kv_mqa__glu_gated_swiglu__prompt_kernel_p4np
  s_lshl_b32 s21, s19, 7
  s_add_u32 s21, s21, 376832
  v_and_b32 v8, 7, v1
  v_lshlrev_b32 v8, 2, v8
  s_mov_b32 s30, 0
adaLN_cond__grouped_kv_mqa__glu_gated_swiglu__prompt_kernel_poll4:
  buffer_load_dword v9, v8, s[4:7], s21 offen offset:0 sc1
  s_add_u32 s30, s30, 1
  s_waitcnt vmcnt(0)
  v_cmp_ne_u32 vcc, s42, v9
  s_nop 1
  s_cbranch_vccz adaLN_cond__grouped_kv_mqa__glu_gated_swiglu__prompt_kernel_poll4d
  s_sleep 1
  s_cmp_lt_u32 s30, 0x20000
  s_cbranch_scc1 adaLN_cond__grouped_kv_mqa__glu_gated_swiglu__prompt_kernel_poll4
adaLN_cond__grouped_kv_mqa__glu_gated_swiglu__prompt_kernel_poll4d:
adaLN_cond__grouped_kv_mqa__glu_gated_swiglu__prompt_kernel_p4np:
  s_and_b32 s24, s2, 1
  s_lshl_b32 s24, s24, 3
  s_add_u32 s24, s24, s22
  s_bfe_u32 s25, s2, 0x20001
  s_lshl_b32 s25, s25, 2
  s_lshr_b32 s21, s2, 6
  s_add_u32 s25, s25, s21
  s_mul_i32 s25, s25, 7
  s_lshl_b32 s27, s18, 13
  s_lshl_b32 s26, s25, 15
  s_add_u32 s26, s26, s27
  s_add_u32 s26, s26, 3145728
  s_cmp_eq_u32 s20, 0
  s_cbranch_scc1 adaLN_cond__grouped_kv_mqa__glu_gated_swiglu__prompt_kernel_p4nl
  s_add_u32 m0, s27, 0
  s_nop 0
  buffer_load_dwordx4 v2, s[4:7], s26 offen offset:0 sc1 lds
  buffer_load_dwordx4 v2, s[4:7], s26 offen offset:1024 sc1 lds
  buffer_load_dwordx4 v2, s[4:7], s26 offen offset:2048 sc1 lds
  buffer_load_dwordx4 v2, s[4:7], s26 offen offset:3072 sc1 lds
  s_add_u32 s26, s26, 4096
  s_add_u32 m0, s27, 4096
  s_nop 0
  buffer_load_dwordx4 v2, s[4:7], s26 offen offset:0 sc1 lds
  buffer_load_dwordx4 v2, s[4:7], s26 offen offset:1024 sc1 lds
  buffer_load_dwordx4 v2, s[4:7], s26 offen offset:2048 sc1 lds
  buffer_load_dwordx4 v2, s[4:7], s26 offen offset:3072 sc1 lds
  s_add_u32 s26, s26, 28672
  s_add_u32 m0, s27, 32768
  s_nop 0
  buffer_load_dwordx4 v2, s[4:7], s26 offen offset:0 sc1 lds
  buffer_load_dwordx4 v2, s[4:7], s26 offen offset:1024 sc1 lds
  buffer_load_dwordx4 v2, s[4:7], s26 offen offset:2048 sc1 lds
  buffer_load_dwordx4 v2, s[4:7], s26 offen offset:3072 sc1 lds
  s_add_u32 s26, s26, 4096
  s_add_u32 m0, s27, 36864
  s_nop 0
  buffer_load_dwordx4 v2, s[4:7], s26 offen offset:0 sc1 lds
  buffer_load_dwordx4 v2, s[4:7], s26 offen offset:1024 sc1 lds
  buffer_load_dwordx4 v2, s[4:7], s26 offen offset:2048 sc1 lds
  buffer_load_dwordx4 v2, s[4:7], s26 offen offset:3072 sc1 lds
  s_add_u32 s26, s26, 28672
adaLN_cond__grouped_kv_mqa__glu_gated_swiglu__prompt_kernel_p4nl:
  s_lshl_b32 s21, s23, 15
  s_add_u32 s21, s21, s27
  s_add_u32 s21, s21, 11534336
  s_barrier
  buffer_load_dwordx4 v[96:99], v2, s[4:7], s21 offen offset:0 sc1
  buffer_load_dwordx4 v[100:103], v2, s[4:7], s21 offen offset:1024 sc1
  buffer_load_dwordx4 v[104:107], v2, s[4:7], s21 offen offset:2048 sc1
  buffer_load_dwordx4 v[108:111], v2, s[4:7], s21 offen offset:3072 sc1
  s_add_u32 s21, s21, 4096
  buffer_load_dwordx4 v[112:115], v2, s[4:7], s21 offen offset:0 sc1
  buffer_load_dwordx4 v[116:119], v2, s[4:7], s21 offen offset:1024 sc1
  buffer_load_dwordx4 v[120:123], v2, s[4:7], s21 offen offset:2048 sc1
  buffer_load_dwordx4 v[124:127], v2, s[4:7], s21 offen offset:3072 sc1
  s_waitcnt vmcnt(7)
  v_mfma_f32_32x32x16_bf16 v[16:31], v[128:131], v[96:99], 0
  v_mfma_f32_32x32x16_bf16 v[32:47], v[160:163], v[96:99], 0
  s_waitcnt vmcnt(6)
  v_mfma_f32_32x32x16_bf16 v[16:31], v[132:135], v[100:103], v[16:31]
  v_mfma_f32_32x32x16_bf16 v[32:47], v[164:167], v[100:103], v[32:47]
  s_waitcnt vmcnt(5)
  v_mfma_f32_32x32x16_bf16 v[16:31], v[136:139], v[104:107], v[16:31]
  v_mfma_f32_32x32x16_bf16 v[32:47], v[168:171], v[104:107], v[32:47]
  s_waitcnt vmcnt(4)
  v_mfma_f32_32x32x16_bf16 v[16:31], v[140:143], v[108:111], v[16:31]
  v_mfma_f32_32x32x16_bf16 v[32:47], v[172:175], v[108:111], v[32:47]
  s_waitcnt vmcnt(3)
  v_mfma_f32_32x32x16_bf16 v[16:31], v[144:147], v[112:115], v[16:31]
  v_mfma_f32_32x32x16_bf16 v[32:47], v[176:179], v[112:115], v[32:47]
  s_waitcnt vmcnt(2)
  v_mfma_f32_32x32x16_bf16 v[16:31], v[148:151], v[116:119], v[16:31]
  v_mfma_f32_32x32x16_bf16 v[32:47], v[180:183], v[116:119], v[32:47]
  s_waitcnt vmcnt(1)
  v_mfma_f32_32x32x16_bf16 v[16:31], v[152:155], v[120:123], v[16:31]
  v_mfma_f32_32x32x16_bf16 v[32:47], v[184:187], v[120:123], v[32:47]
  s_waitcnt vmcnt(0)
  v_mfma_f32_32x32x16_bf16 v[16:31], v[156:159], v[124:127], v[16:31]
  v_mfma_f32_32x32x16_bf16 v[32:47], v[188:191], v[124:127], v[32:47]
  s_lshl_b32 s21, s20, 15
  s_lshl_b32 s29, s18, 11
  s_add_u32 s29, s29, s21
  s_add_u32 s29, s29, 98304
  v_add_u32 v8, s29, v2
  s_lshl_b32 s29, s18, 13
  s_add_u32 s29, s29, s21
  s_add_u32 s29, s29, 98304
  v_add_u32 v9, s29, v2
  s_nop 4
  ds_write_b128 v8, v[16:19] offset:0
  ds_write_b128 v8, v[20:23] offset:1024
  ds_write_b128 v8, v[24:27] offset:8192
  ds_write_b128 v8, v[28:31] offset:9216
  ds_write_b128 v8, v[32:35] offset:16384
  ds_write_b128 v8, v[36:39] offset:17408
  ds_write_b128 v8, v[40:43] offset:24576
  ds_write_b128 v8, v[44:47] offset:25600
  s_waitcnt lgkmcnt(0)
  s_barrier
  ds_read_b128 v[96:99], v9 offset:0
  ds_read_b128 v[100:103], v9 offset:1024
  ds_read_b128 v[104:107], v9 offset:2048
  ds_read_b128 v[108:111], v9 offset:3072
  ds_read_b128 v[112:115], v9 offset:4096
  ds_read_b128 v[116:119], v9 offset:5120
  ds_read_b128 v[120:123], v9 offset:6144
  ds_read_b128 v[124:127], v9 offset:7168
  s_waitcnt lgkmcnt(4)
  v_add_f32 v48, v96, v104
  v_add_f32 v49, v97, v105
  v_add_f32 v50, v98, v106
  v_add_f32 v51, v99, v107
  v_add_f32 v52, v100, v108
  v_add_f32 v53, v101, v109
  v_add_f32 v54, v102, v110
  v_add_f32 v55, v103, v111
  s_waitcnt lgkmcnt(0)
  v_add_f32 v112, v112, v120
  v_add_f32 v113, v113, v121
  v_add_f32 v114, v114, v122
  v_add_f32 v115, v115, v123
  v_add_f32 v116, v116, v124
  v_add_f32 v117, v117, v125
  v_add_f32 v118, v118, v126
  v_add_f32 v119, v119, v127
  v_add_f32 v48, v48, v112
  v_add_f32 v49, v49, v113
  v_add_f32 v50, v50, v114
  v_add_f32 v51, v51, v115
  v_add_f32 v52, v52, v116
  v_add_f32 v53, v53, v117
  v_add_f32 v54, v54, v118
  v_add_f32 v55, v55, v119
  v_lshlrev_b32 v96, 16, v192
  v_and_b32 v97, 0xffff0000, v192
  v_lshlrev_b32 v98, 16, v193
  v_and_b32 v99, 0xffff0000, v193
  v_lshlrev_b32 v100, 16, v194
  v_and_b32 v101, 0xffff0000, v194
  v_lshlrev_b32 v102, 16, v195
  v_and_b32 v103, 0xffff0000, v195
  v_fma_f32 v48, v48, v196, v96
  v_fma_f32 v49, v49, v197, v97
  v_fma_f32 v50, v50, v198, v98
  v_fma_f32 v51, v51, v199, v99
  v_fma_f32 v52, v52, v200, v100
  v_fma_f32 v53, v53, v201, v101
  v_fma_f32 v54, v54, v202, v102
  v_fma_f32 v55, v55, v203, v103
  v_cvt_pk_bf16_f32 v12, v48, v49
  v_cvt_pk_bf16_f32 v13, v50, v51
  v_cvt_pk_bf16_f32 v14, v52, v53
  v_cvt_pk_bf16_f32 v15, v54, v55
  v_lshlrev_b32 v48, 16, v12
  v_and_b32 v49, 0xffff0000, v12
  v_lshlrev_b32 v50, 16, v13
  v_and_b32 v51, 0xffff0000, v13
  v_lshlrev_b32 v52, 16, v14
  v_and_b32 v53, 0xffff0000, v14
  v_lshlrev_b32 v54, 16, v15
  v_and_b32 v55, 0xffff0000, v15
  v_mul_f32 v48, v48, v204
  v_mul_f32 v49, v49, v205
  v_mul_f32 v50, v50, v206
  v_mul_f32 v51, v51, v207
  v_mul_f32 v52, v52, v208
  v_mul_f32 v53, v53, v209
  v_mul_f32 v54, v54, v210
  v_mul_f32 v55, v55, v211
  v_cvt_pk_bf16_f32 v96, v48, v49
  v_cvt_pk_bf16_f32 v97, v50, v51
  v_cvt_pk_bf16_f32 v98, v52, v53
  v_cvt_pk_bf16_f32 v99, v54, v55
  s_lshl_b32 s21, s23, 5
  s_add_u32 s21, s21, s31
  s_lshl_b32 s21, s21, 10
  s_add_u32 s21, s21, 15728640
  buffer_store_dwordx4 v[96:99], v2, s[4:7], s21 offen sc1
  s_mov_b32 s29, 0x3f803f80
  v_mov_b32 v8, 0
  v_mov_b32 v9, 0
  v_dot2_f32_bf16 v8, v12, s29, v8
  v_dot2_f32_bf16 v9, v12, v12, v9
  v_dot2_f32_bf16 v8, v13, s29, v8
  v_dot2_f32_bf16 v9, v13, v13, v9
  v_dot2_f32_bf16 v8, v14, s29, v8
  v_dot2_f32_bf16 v9, v14, v14, v9
  v_dot2_f32_bf16 v8, v15, s29, v8
  v_dot2_f32_bf16 v9, v15, v15, v9
  s_nop 2
  v_mov_b32 v10, v8
  v_mov_b32 v11, v9
  s_nop 1
  v_permlane32_swap_b32 v8, v10
  v_permlane32_swap_b32 v9, v11
  v_add_f32 v8, v8, v10
  v_add_f32 v9, v9, v11
  v_lshlrev_b32 v10, 3, v4
  s_lshl_b32 s21, s23, 5
  s_add_u32 s21, s21, s31
  s_lshl_b32 s21, s21, 8
  s_add_u32 s21, s21, 25165824
  s_mov_b32 exec_hi, 0
  buffer_store_dwordx2 v[8:9], v10, s[4:7], s21 offen sc1
  s_mov_b64 exec, -1
  s_waitcnt vmcnt(0)
  s_barrier
  s_cmp_eq_u32 s20, 1
  s_cbranch_scc1 adaLN_cond__grouped_kv_mqa__glu_gated_swiglu__prompt_kernel_ldr
  s_cmp_lg_u32 s3, 0
  s_cbranch_scc1 adaLN_cond__grouped_kv_mqa__glu_gated_swiglu__prompt_kernel_p5np
  s_lshr_b32 s21, s19, 1
  s_lshl_b32 s21, s21, 5
  s_and_b32 s29, s19, 1
  s_lshl_b32 s29, s29, 3
  s_add_u32 s21, s21, s29
  s_add_u32 s21, s21, s22
  s_lshl_b32 s21, s21, 2
  s_add_u32 s21, s21, 380928
  s_mov_b64 exec, 1
  v_lshlrev_b32 v8, 9, v1
  v_mov_b32 v9, s42
  buffer_store_dword v9, v8, s[4:7], s21 offen sc1
  s_mov_b64 exec, -1
  s_lshl_b32 s21, s24, 7
  s_add_u32 s21, s21, 380928
  v_and_b32 v8, 15, v1
  v_lshlrev_b32 v8, 2, v8
  s_mov_b32 s30, 0
adaLN_cond__grouped_kv_mqa__glu_gated_swiglu__prompt_kernel_poll5:
  buffer_load_dword v9, v8, s[4:7], s21 offen offset:0 sc1
  s_add_u32 s30, s30, 1
  s_waitcnt vmcnt(0)
  v_cmp_ne_u32 vcc, s42, v9
  s_nop 1
  s_cbranch_vccz adaLN_cond__grouped_kv_mqa__glu_gated_swiglu__prompt_kernel_poll5d
  s_sleep 1
  s_cmp_lt_u32 s30, 0x20000
  s_cbranch_scc1 adaLN_cond__grouped_kv_mqa__glu_gated_swiglu__prompt_kernel_poll5
adaLN_cond__grouped_kv_mqa__glu_gated_swiglu__prompt_kernel_poll5d:
adaLN_cond__grouped_kv_mqa__glu_gated_swiglu__prompt_kernel_p5np:
  s_lshl_b32 s29, s24, 2
  s_add_u32 s29, s29, s18
  s_lshl_b32 s21, s29, 15
  s_add_u32 s21, s21, 15728640
  s_mul_i32 s29, s29, 112
  s_add_u32 s29, s29, s25
  s_lshl_b32 s29, s29, 10
  s_add_u32 s29, s29, 17825792
  v_mov_b32 v7, v2
  v_lshlrev_b32 v10, 6, v3
  v_add_u32 v10, 147456, v10
  s_lshl_b32 s27, s18, 8
  s_add_u32 s27, s27, 149504
  v_lshl_add_u32 v11, v4, 3, s27
  s_barrier
  buffer_load_dwordx4 v[128:131], v2, s[4:7], s21 offen offset:0 sc1
  buffer_load_dwordx4 v[132:135], v2, s[4:7], s21 offen offset:1024 sc1
  buffer_load_dwordx4 v[136:139], v2, s[4:7], s21 offen offset:2048 sc1
  buffer_load_dwordx4 v[140:143], v2, s[4:7], s21 offen offset:3072 sc1
  s_add_u32 s21, s21, 4096
  buffer_load_dwordx4 v[144:147], v2, s[4:7], s21 offen offset:0 sc1
  buffer_load_dwordx4 v[148:151], v2, s[4:7], s21 offen offset:1024 sc1
  buffer_load_dwordx4 v[152:155], v2, s[4:7], s21 offen offset:2048 sc1
  buffer_load_dwordx4 v[156:159], v2, s[4:7], s21 offen offset:3072 sc1
  s_add_u32 s21, s21, 4096
  buffer_load_dwordx4 v[160:163], v2, s[4:7], s21 offen offset:0 sc1
  buffer_load_dwordx4 v[164:167], v2, s[4:7], s21 offen offset:1024 sc1
  ds_read_b128 v[48:51], v7 offset:0
  ds_read_b128 v[52:55], v7 offset:32768
  ds_read_b128 v[56:59], v7 offset:1024
  ds_read_b128 v[60:63], v7 offset:33792
  ds_read_b128 v[64:67], v7 offset:2048
  ds_read_b128 v[68:71], v7 offset:34816
  ds_read_b128 v[72:75], v7 offset:3072
  ds_read_b128 v[76:79], v7 offset:35840
  s_waitcnt vmcnt(9) lgkmcnt(7)
  v_mfma_f32_32x32x16_bf16 v[16:31], v[48:51], v[128:131], 0
  ds_read_b128 v[48:51], v7 offset:4096
  s_waitcnt lgkmcnt(7)
  v_mfma_f32_32x32x16_bf16 v[32:47], v[52:55], v[128:131], 0
  ds_read_b128 v[52:55], v7 offset:36864
  buffer_load_dwordx4 v[168:171], v2, s[4:7], s21 offen offset:2048 sc1
  s_waitcnt vmcnt(9) lgkmcnt(7)
  v_mfma_f32_32x32x16_bf16 v[16:31], v[56:59], v[132:135], v[16:31]
  ds_read_b128 v[56:59], v7 offset:5120
  s_waitcnt lgkmcnt(7)
  v_mfma_f32_32x32x16_bf16 v[32:47], v[60:63], v[132:135], v[32:47]
  ds_read_b128 v[60:63], v7 offset:37888
  buffer_load_dwordx4 v[172:175], v2, s[4:7], s21 offen offset:3072 sc1
  s_add_u32 s21, s21, 4096
  s_waitcnt vmcnt(9) lgkmcnt(7)
  v_mfma_f32_32x32x16_bf16 v[16:31], v[64:67], v[136:139], v[16:31]
  ds_read_b128 v[64:67], v7 offset:6144
  s_waitcnt lgkmcnt(7)
  v_mfma_f32_32x32x16_bf16 v[32:47], v[68:71], v[136:139], v[32:47]
  ds_read_b128 v[68:71], v7 offset:38912
  buffer_load_dwordx4 v[176:179], v2, s[4:7], s21 offen offset:0 sc1
  s_waitcnt vmcnt(9) lgkmcnt(7)
  v_mfma_f32_32x32x16_bf16 v[16:31], v[72:75], v[140:143], v[16:31]
  ds_read_b128 v[72:75], v7 offset:7168
  s_waitcnt lgkmcnt(7)
  v_mfma_f32_32x32x16_bf16 v[32:47], v[76:79], v[140:143], v[32:47]
  ds_read_b128 v[76:79], v7 offset:39936
  buffer_load_dwordx4 v[180:183], v2, s[4:7], s21 offen offset:1024 sc1
  s_waitcnt vmcnt(9) lgkmcnt(7)
  v_mfma_f32_32x32x16_bf16 v[16:31], v[48:51], v[144:147], v[16:31]
  ds_read_b128 v[48:51], v7 offset:8192
  s_waitcnt lgkmcnt(7)
  v_mfma_f32_32x32x16_bf16 v[32:47], v[52:55], v[144:147], v[32:47]
  ds_read_b128 v[52:55], v7 offset:40960
  buffer_load_dwordx4 v[184:187], v2, s[4:7], s21 offen offset:2048 sc1
  s_waitcnt vmcnt(9) lgkmcnt(7)
  v_mfma_f32_32x32x16_bf16 v[16:31], v[56:59], v[148:151], v[16:31]
  ds_read_b128 v[56:59], v7 offset:9216
  s_waitcnt lgkmcnt(7)
  v_mfma_f32_32x32x16_bf16 v[32:47], v[60:63], v[148:151], v[32:47]
  ds_read_b128 v[60:63], v7 offset:41984
  buffer_load_dwordx4 v[188:191], v2, s[4:7], s21 offen offset:3072 sc1
  s_add_u32 s21, s21, 4096
  s_waitcnt vmcnt(9) lgkmcnt(7)
  v_mfma_f32_32x32x16_bf16 v[16:31], v[64:67], v[152:155], v[16:31]
  ds_read_b128 v[64:67], v7 offset:10240
  s_waitcnt lgkmcnt(7)
  v_mfma_f32_32x32x16_bf16 v[32:47], v[68:71], v[152:155], v[32:47]
  ds_read_b128 v[68:71], v7 offset:43008
  buffer_load_dwordx4 v[192:195], v2, s[4:7], s21 offen offset:0 sc1
  s_waitcnt vmcnt(9) lgkmcnt(7)
  v_mfma_f32_32x32x16_bf16 v[16:31], v[72:75], v[156:159], v[16:31]
  ds_read_b128 v[72:75], v7 offset:11264
  s_waitcnt lgkmcnt(7)
  v_mfma_f32_32x32x16_bf16 v[32:47], v[76:79], v[156:159], v[32:47]
  ds_read_b128 v[76:79], v7 offset:44032
  buffer_load_dwordx4 v[196:199], v2, s[4:7], s21 offen offset:1024 sc1
  s_waitcnt vmcnt(9) lgkmcnt(7)
  v_mfma_f32_32x32x16_bf16 v[16:31], v[48:51], v[160:163], v[16:31]
  ds_read_b128 v[48:51], v7 offset:12288
  s_waitcnt lgkmcnt(7)
  v_mfma_f32_32x32x16_bf16 v[32:47], v[52:55], v[160:163], v[32:47]
  ds_read_b128 v[52:55], v7 offset:45056
  buffer_load_dwordx4 v[200:203], v2, s[4:7], s21 offen offset:2048 sc1
  s_waitcnt vmcnt(9) lgkmcnt(7)
  v_mfma_f32_32x32x16_bf16 v[16:31], v[56:59], v[164:167], v[16:31]
  ds_read_b128 v[56:59], v7 offset:13312
  s_waitcnt lgkmcnt(7)
  v_mfma_f32_32x32x16_bf16 v[32:47], v[60:63], v[164:167], v[32:47]
  ds_read_b128 v[60:63], v7 offset:46080
  buffer_load_dwordx4 v[204:207], v2, s[4:7], s21 offen offset:3072 sc1
  s_add_u32 s21, s21, 4096
  s_waitcnt vmcnt(9) lgkmcnt(7)
  v_mfma_f32_32x32x16_bf16 v[16:31], v[64:67], v[168:171], v[16:31]
  ds_read_b128 v[64:67], v7 offset:14336
  s_waitcnt lgkmcnt(7)
  v_mfma_f32_32x32x16_bf16 v[32:47], v[68:71], v[168:171], v[32:47]
  ds_read_b128 v[68:71], v7 offset:47104
  buffer_load_dwordx4 v[208:211], v2, s[4:7], s21 offen offset:0 sc1
  s_waitcnt vmcnt(9) lgkmcnt(7)
  v_mfma_f32_32x32x16_bf16 v[16:31], v[72:75], v[172:175], v[16:31]
  ds_read_b128 v[72:75], v7 offset:15360
  s_waitcnt lgkmcnt(7)
  v_mfma_f32_32x32x16_bf16 v[32:47], v[76:79], v[172:175], v[32:47]
  ds_read_b128 v[76:79], v7 offset:48128
  buffer_load_dwordx4 v[212:215], v2, s[4:7], s21 offen offset:1024 sc1
  s_waitcnt vmcnt(9) lgkmcnt(7)
  v_mfma_f32_32x32x16_bf16 v[16:31], v[48:51], v[176:179], v[16:31]
  ds_read_b128 v[48:51], v7 offset:16384
  s_waitcnt lgkmcnt(7)
  v_mfma_f32_32x32x16_bf16 v[32:47], v[52:55], v[176:179], v[32:47]
  ds_read_b128 v[52:55], v7 offset:49152
  buffer_load_dwordx4 v[216:219], v2, s[4:7], s21 offen offset:2048 sc1
  s_waitcnt vmcnt(9) lgkmcnt(7)
  v_mfma_f32_32x32x16_bf16 v[16:31], v[56:59], v[180:183], v[16:31]
  ds_read_b128 v[56:59], v7 offset:17408
  s_waitcnt lgkmcnt(7)
  v_mfma_f32_32x32x16_bf16 v[32:47], v[60:63], v[180:183], v[32:47]
  ds_read_b128 v[60:63], v7 offset:50176
  buffer_load_dwordx4 v[220:223], v2, s[4:7], s21 offen offset:3072 sc1
  s_add_u32 s21, s21, 4096
  s_waitcnt vmcnt(9) lgkmcnt(7)
  v_mfma_f32_32x32x16_bf16 v[16:31], v[64:67], v[184:187], v[16:31]
  ds_read_b128 v[64:67], v7 offset:18432
  s_waitcnt lgkmcnt(7)
  v_mfma_f32_32x32x16_bf16 v[32:47], v[68:71], v[184:187], v[32:47]
  ds_read_b128 v[68:71], v7 offset:51200
  buffer_load_dwordx4 v[224:227], v2, s[4:7], s21 offen offset:0 sc1
  s_waitcnt vmcnt(9) lgkmcnt(7)
  v_mfma_f32_32x32x16_bf16 v[16:31], v[72:75], v[188:191], v[16:31]
  ds_read_b128 v[72:75], v7 offset:19456
  s_waitcnt lgkmcnt(7)
  v_mfma_f32_32x32x16_bf16 v[32:47], v[76:79], v[188:191], v[32:47]
  ds_read_b128 v[76:79], v7 offset:52224
  buffer_load_dwordx4 v[228:231], v2, s[4:7], s21 offen offset:1024 sc1
  s_waitcnt vmcnt(9) lgkmcnt(7)
  v_mfma_f32_32x32x16_bf16 v[16:31], v[48:51], v[192:195], v[16:31]
  ds_read_b128 v[48:51], v7 offset:20480
  s_waitcnt lgkmcnt(7)
  v_mfma_f32_32x32x16_bf16 v[32:47], v[52:55], v[192:195], v[32:47]
  ds_read_b128 v[52:55], v7 offset:53248
  buffer_load_dwordx4 v[232:235], v2, s[4:7], s21 offen offset:2048 sc1
  s_waitcnt vmcnt(9) lgkmcnt(7)
  v_mfma_f32_32x32x16_bf16 v[16:31], v[56:59], v[196:199], v[16:31]
  ds_read_b128 v[56:59], v7 offset:21504
  s_waitcnt lgkmcnt(7)
  v_mfma_f32_32x32x16_bf16 v[32:47], v[60:63], v[196:199], v[32:47]
  ds_read_b128 v[60:63], v7 offset:54272
  buffer_load_dwordx4 v[236:239], v2, s[4:7], s21 offen offset:3072 sc1
  s_add_u32 s21, s21, 4096
  s_waitcnt vmcnt(9) lgkmcnt(7)
  v_mfma_f32_32x32x16_bf16 v[16:31], v[64:67], v[200:203], v[16:31]
  ds_read_b128 v[64:67], v7 offset:22528
  s_waitcnt lgkmcnt(7)
  v_mfma_f32_32x32x16_bf16 v[32:47], v[68:71], v[200:203], v[32:47]
  ds_read_b128 v[68:71], v7 offset:55296
  buffer_load_dwordx4 v[240:243], v2, s[4:7], s21 offen offset:0 sc1
  s_waitcnt vmcnt(9) lgkmcnt(7)
  v_mfma_f32_32x32x16_bf16 v[16:31], v[72:75], v[204:207], v[16:31]
  ds_read_b128 v[72:75], v7 offset:23552
  s_waitcnt lgkmcnt(7)
  v_mfma_f32_32x32x16_bf16 v[32:47], v[76:79], v[204:207], v[32:47]
  ds_read_b128 v[76:79], v7 offset:56320
  buffer_load_dwordx4 v[244:247], v2, s[4:7], s21 offen offset:1024 sc1
  s_waitcnt vmcnt(9) lgkmcnt(7)
  v_mfma_f32_32x32x16_bf16 v[16:31], v[48:51], v[208:211], v[16:31]
  ds_read_b128 v[48:51], v7 offset:24576
  s_waitcnt lgkmcnt(7)
  v_mfma_f32_32x32x16_bf16 v[32:47], v[52:55], v[208:211], v[32:47]
  ds_read_b128 v[52:55], v7 offset:57344
  buffer_load_dwordx4 v[248:251], v2, s[4:7], s21 offen offset:2048 sc1
  s_waitcnt vmcnt(9) lgkmcnt(7)
  v_mfma_f32_32x32x16_bf16 v[16:31], v[56:59], v[212:215], v[16:31]
  ds_read_b128 v[56:59], v7 offset:25600
  s_waitcnt lgkmcnt(7)
  v_mfma_f32_32x32x16_bf16 v[32:47], v[60:63], v[212:215], v[32:47]
  ds_read_b128 v[60:63], v7 offset:58368
  buffer_load_dwordx4 v[252:255], v2, s[4:7], s21 offen offset:3072 sc1
  s_add_u32 s21, s21, 4096
  s_waitcnt vmcnt(9) lgkmcnt(7)
  v_mfma_f32_32x32x16_bf16 v[16:31], v[64:67], v[216:219], v[16:31]
  ds_read_b128 v[64:67], v7 offset:26624
  s_waitcnt lgkmcnt(7)
  v_mfma_f32_32x32x16_bf16 v[32:47], v[68:71], v[216:219], v[32:47]
  ds_read_b128 v[68:71], v7 offset:59392
  s_waitcnt vmcnt(8) lgkmcnt(7)
  v_mfma_f32_32x32x16_bf16 v[16:31], v[72:75], v[220:223], v[16:31]
  ds_read_b128 v[72:75], v7 offset:27648
  s_waitcnt lgkmcnt(7)
  v_mfma_f32_32x32x16_bf16 v[32:47], v[76:79], v[220:223], v[32:47]
  ds_read_b128 v[76:79], v7 offset:60416
  s_waitcnt vmcnt(7) lgkmcnt(7)
  v_mfma_f32_32x32x16_bf16 v[16:31], v[48:51], v[224:227], v[16:31]
  ds_read_b128 v[48:51], v7 offset:28672
  s_waitcnt lgkmcnt(7)
  v_mfma_f32_32x32x16_bf16 v[32:47], v[52:55], v[224:227], v[32:47]
  ds_read_b128 v[52:55], v7 offset:61440
  s_waitcnt vmcnt(6) lgkmcnt(7)
  v_mfma_f32_32x32x16_bf16 v[16:31], v[56:59], v[228:231], v[16:31]
  ds_read_b128 v[56:59], v7 offset:29696
  s_waitcnt lgkmcnt(7)
  v_mfma_f32_32x32x16_bf16 v[32:47], v[60:63], v[228:231], v[32:47]
  ds_read_b128 v[60:63], v7 offset:62464
  s_waitcnt vmcnt(5) lgkmcnt(7)
  v_mfma_f32_32x32x16_bf16 v[16:31], v[64:67], v[232:235], v[16:31]
  ds_read_b128 v[64:67], v7 offset:30720
  s_waitcnt lgkmcnt(7)
  v_mfma_f32_32x32x16_bf16 v[32:47], v[68:71], v[232:235], v[32:47]
  ds_read_b128 v[68:71], v7 offset:63488
  s_waitcnt vmcnt(4) lgkmcnt(7)
  v_mfma_f32_32x32x16_bf16 v[16:31], v[72:75], v[236:239], v[16:31]
  ds_read_b128 v[72:75], v7 offset:31744
  s_waitcnt lgkmcnt(7)
  v_mfma_f32_32x32x16_bf16 v[32:47], v[76:79], v[236:239], v[32:47]
  ds_read_b128 v[76:79], v7 offset:64512
  s_waitcnt vmcnt(3) lgkmcnt(7)
  v_mfma_f32_32x32x16_bf16 v[16:31], v[48:51], v[240:243], v[16:31]
  s_waitcnt lgkmcnt(6)
  v_mfma_f32_32x32x16_bf16 v[32:47], v[52:55], v[240:243], v[32:47]
  s_waitcnt vmcnt(2) lgkmcnt(5)
  v_mfma_f32_32x32x16_bf16 v[16:31], v[56:59], v[244:247], v[16:31]
  s_waitcnt lgkmcnt(4)
  v_mfma_f32_32x32x16_bf16 v[32:47], v[60:63], v[244:247], v[32:47]
  s_waitcnt vmcnt(1) lgkmcnt(3)
  v_mfma_f32_32x32x16_bf16 v[16:31], v[64:67], v[248:251], v[16:31]
  s_waitcnt lgkmcnt(2)
  v_mfma_f32_32x32x16_bf16 v[32:47], v[68:71], v[248:251], v[32:47]
  s_waitcnt vmcnt(0) lgkmcnt(1)
  v_mfma_f32_32x32x16_bf16 v[16:31], v[72:75], v[252:255], v[16:31]
  s_waitcnt lgkmcnt(0)
  v_mfma_f32_32x32x16_bf16 v[32:47], v[76:79], v[252:255], v[32:47]
  v_add_u32 v7, 65536, v7
  s_barrier
  ds_read_b64 v[8:9], v11
  ds_read_b128 v[80:83], v10 offset:0
  ds_read_b128 v[84:87], v10 offset:16
  ds_read_b128 v[88:91], v10 offset:32
  ds_read_b128 v[92:95], v10 offset:48
  ds_read_b128 v[96:99], v10 offset:128
  ds_read_b128 v[100:103], v10 offset:144
  ds_read_b128 v[104:107], v10 offset:160
  ds_read_b128 v[108:111], v10 offset:176
  v_add_u32 v10, 256, v10
  ds_read_b128 v[48:51], v7 offset:0
  ds_read_b128 v[52:55], v7 offset:1024
  ds_read_b128 v[56:59], v7 offset:2048
  ds_read_b128 v[60:63], v7 offset:3072
  ds_read_b128 v[64:67], v7 offset:4096
  ds_read_b128 v[68:71], v7 offset:5120
  s_waitcnt lgkmcnt(6)
  ds_read_b128 v[72:75], v7 offset:6144
  ds_read_b128 v[76:79], v7 offset:7168
  v_fma_f32 v96, -v9, v80, v96
  v_fma_f32 v97, -v9, v81, v97
  v_fma_f32 v98, -v9, v82, v98
  v_fma_f32 v99, -v9, v83, v99
  v_fma_f32 v100, -v9, v84, v100
  v_fma_f32 v101, -v9, v85, v101
  v_fma_f32 v102, -v9, v86, v102
  v_fma_f32 v103, -v9, v87, v103
  v_fma_f32 v104, -v9, v88, v104
  v_fma_f32 v105, -v9, v89, v105
  v_fma_f32 v106, -v9, v90, v106
  v_fma_f32 v107, -v9, v91, v107
  v_fma_f32 v108, -v9, v92, v108
  v_fma_f32 v109, -v9, v93, v109
  v_fma_f32 v110, -v9, v94, v110
  v_fma_f32 v111, -v9, v95, v111
  v_fma_f32 v112, v16, v8, v96
  v_fma_f32 v113, v17, v8, v97
  v_fma_f32 v114, v18, v8, v98
  v_fma_f32 v115, v19, v8, v99
  v_fma_f32 v116, v20, v8, v100
  v_fma_f32 v117, v21, v8, v101
  v_fma_f32 v118, v22, v8, v102
  v_fma_f32 v119, v23, v8, v103
  v_fma_f32 v120, v24, v8, v104
  v_fma_f32 v121, v25, v8, v105
  v_fma_f32 v122, v26, v8, v106
  v_fma_f32 v123, v27, v8, v107
  v_fma_f32 v124, v28, v8, v108
  v_fma_f32 v125, v29, v8, v109
  v_fma_f32 v126, v30, v8, v110
  v_fma_f32 v127, v31, v8, v111
  v_mul_f32 v80, 0xbfb8aa3b, v112
  v_mul_f32 v81, 0xbfb8aa3b, v113
  v_mul_f32 v82, 0xbfb8aa3b, v114
  v_mul_f32 v83, 0xbfb8aa3b, v115
  v_mul_f32 v84, 0xbfb8aa3b, v116
  v_mul_f32 v85, 0xbfb8aa3b, v117
  v_mul_f32 v86, 0xbfb8aa3b, v118
  v_mul_f32 v87, 0xbfb8aa3b, v119
  v_exp_f32 v80, v80
  v_exp_f32 v81, v81
  v_exp_f32 v82, v82
  v_exp_f32 v83, v83
  v_exp_f32 v84, v84
  v_exp_f32 v85, v85
  v_exp_f32 v86, v86
  v_exp_f32 v87, v87
  v_mul_f32 v112, v112, v120
  v_mul_f32 v113, v113, v121
  v_mul_f32 v114, v114, v122
  v_mul_f32 v115, v115, v123
  v_mul_f32 v116, v116, v124
  v_mul_f32 v117, v117, v125
  v_mul_f32 v118, v118, v126
  v_mul_f32 v119, v119, v127
  v_add_f32 v80, 1.0, v80
  v_add_f32 v81, 1.0, v81
  v_add_f32 v82, 1.0, v82
  v_add_f32 v83, 1.0, v83
  v_add_f32 v84, 1.0, v84
  v_add_f32 v85, 1.0, v85
  v_add_f32 v86, 1.0, v86
  v_add_f32 v87, 1.0, v87
  v_rcp_f32 v80, v80
  v_rcp_f32 v81, v81
  v_rcp_f32 v82, v82
  v_rcp_f32 v83, v83
  v_rcp_f32 v84, v84
  v_rcp_f32 v85, v85
  v_rcp_f32 v86, v86
  v_rcp_f32 v87, v87
  v_mul_f32 v112, v112, v80
  v_mul_f32 v113, v113, v81
  v_mul_f32 v114, v114, v82
  v_mul_f32 v115, v115, v83
  v_mul_f32 v116, v116, v84
  v_mul_f32 v117, v117, v85
  v_mul_f32 v118, v118, v86
  v_mul_f32 v119, v119, v87
  v_cvt_pk_bf16_f32 v120, v112, v113
  v_cvt_pk_bf16_f32 v121, v114, v115
  v_cvt_pk_bf16_f32 v122, v116, v117
  v_cvt_pk_bf16_f32 v123, v118, v119
  buffer_store_dwordx4 v[120:123], v2, s[4:7], s29 offen sc1
  s_add_u32 s29, s29, 1024
  s_mov_b32 s30, 0
  s_branch adaLN_cond__grouped_kv_mqa__glu_gated_swiglu__prompt_kernel_p5mid
adaLN_cond__grouped_kv_mqa__glu_gated_swiglu__prompt_kernel_p5loop:
  ds_read_b64 v[8:9], v11
  ds_read_b128 v[80:83], v10 offset:0
  ds_read_b128 v[84:87], v10 offset:16
  ds_read_b128 v[88:91], v10 offset:32
  ds_read_b128 v[92:95], v10 offset:48
  ds_read_b128 v[96:99], v10 offset:128
  ds_read_b128 v[100:103], v10 offset:144
  ds_read_b128 v[104:107], v10 offset:160
  ds_read_b128 v[108:111], v10 offset:176
  v_add_u32 v10, 256, v10
  s_waitcnt lgkmcnt(15)
  v_mfma_f32_32x32x16_bf16 v[32:47], v[48:51], v[128:131], 0
  ds_read_b128 v[48:51], v7 offset:8192
  s_waitcnt lgkmcnt(15)
  v_mfma_f32_32x32x16_bf16 v[32:47], v[52:55], v[132:135], v[32:47]
  ds_read_b128 v[52:55], v7 offset:9216
  s_waitcnt lgkmcnt(15)
  v_mfma_f32_32x32x16_bf16 v[32:47], v[56:59], v[136:139], v[32:47]
  ds_read_b128 v[56:59], v7 offset:10240
  s_waitcnt lgkmcnt(3)
  v_mfma_f32_32x32x16_bf16 v[32:47], v[60:63], v[140:143], v[32:47]
  ds_read_b128 v[60:63], v7 offset:11264
  v_fma_f32 v96, -v9, v80, v96
  v_fma_f32 v97, -v9, v81, v97
  v_fma_f32 v98, -v9, v82, v98
  v_fma_f32 v99, -v9, v83, v99
  s_waitcnt lgkmcnt(7)
  v_mfma_f32_32x32x16_bf16 v[32:47], v[64:67], v[144:147], v[32:47]
  ds_read_b128 v[64:67], v7 offset:12288
  v_fma_f32 v100, -v9, v84, v100
  v_fma_f32 v101, -v9, v85, v101
  v_fma_f32 v102, -v9, v86, v102
  v_fma_f32 v103, -v9, v87, v103
  s_waitcnt lgkmcnt(7)
  v_mfma_f32_32x32x16_bf16 v[32:47], v[68:71], v[148:151], v[32:47]
  ds_read_b128 v[68:71], v7 offset:13312
  v_fma_f32 v104, -v9, v88, v104
  v_fma_f32 v105, -v9, v89, v105
  v_fma_f32 v106, -v9, v90, v106
  v_fma_f32 v107, -v9, v91, v107
  s_waitcnt lgkmcnt(7)
  v_mfma_f32_32x32x16_bf16 v[32:47], v[72:75], v[152:155], v[32:47]
  ds_read_b128 v[72:75], v7 offset:14336
  v_fma_f32 v108, -v9, v92, v108
  v_fma_f32 v109, -v9, v93, v109
  v_fma_f32 v110, -v9, v94, v110
  v_fma_f32 v111, -v9, v95, v111
  s_waitcnt lgkmcnt(7)
  v_mfma_f32_32x32x16_bf16 v[32:47], v[76:79], v[156:159], v[32:47]
  ds_read_b128 v[76:79], v7 offset:15360
  v_fma_f32 v112, v16, v8, v96
  v_fma_f32 v113, v17, v8, v97
  v_fma_f32 v114, v18, v8, v98
  v_fma_f32 v115, v19, v8, v99
  s_waitcnt lgkmcnt(7)
  v_mfma_f32_32x32x16_bf16 v[32:47], v[48:51], v[160:163], v[32:47]
  ds_read_b128 v[48:51], v7 offset:16384
  v_fma_f32 v116, v20, v8, v100
  v_fma_f32 v117, v21, v8, v101
  v_fma_f32 v118, v22, v8, v102
  v_fma_f32 v119, v23, v8, v103
  s_waitcnt lgkmcnt(7)
  v_mfma_f32_32x32x16_bf16 v[32:47], v[52:55], v[164:167], v[32:47]
  ds_read_b128 v[52:55], v7 offset:17408
  v_fma_f32 v120, v24, v8, v104
  v_fma_f32 v121, v25, v8, v105
  v_fma_f32 v122, v26, v8, v106
  v_fma_f32 v123, v27, v8, v107
  s_waitcnt lgkmcnt(7)
  v_mfma_f32_32x32x16_bf16 v[32:47], v[56:59], v[168:171], v[32:47]
  ds_read_b128 v[56:59], v7 offset:18432
  v_fma_f32 v124, v28, v8, v108
  v_fma_f32 v125, v29, v8, v109
  v_fma_f32 v126, v30, v8, v110
  v_fma_f32 v127, v31, v8, v111
  s_waitcnt lgkmcnt(7)
  v_mfma_f32_32x32x16_bf16 v[32:47], v[60:63], v[172:175], v[32:47]
  ds_read_b128 v[60:63], v7 offset:19456
  v_mul_f32 v80, 0xbfb8aa3b, v112
  v_mul_f32 v81, 0xbfb8aa3b, v113
  v_mul_f32 v82, 0xbfb8aa3b, v114
  v_mul_f32 v83, 0xbfb8aa3b, v115
  s_waitcnt lgkmcnt(7)
  v_mfma_f32_32x32x16_bf16 v[32:47], v[64:67], v[176:179], v[32:47]
  ds_read_b128 v[64:67], v7 offset:20480
  v_mul_f32 v84, 0xbfb8aa3b, v116
  v_mul_f32 v85, 0xbfb8aa3b, v117
  v_mul_f32 v86, 0xbfb8aa3b, v118
  v_mul_f32 v87, 0xbfb8aa3b, v119
  s_waitcnt lgkmcnt(7)
  v_mfma_f32_32x32x16_bf16 v[32:47], v[68:71], v[180:183], v[32:47]
  ds_read_b128 v[68:71], v7 offset:21504
  v_exp_f32 v80, v80
  v_exp_f32 v81, v81
  s_waitcnt lgkmcnt(7)
  v_mfma_f32_32x32x16_bf16 v[32:47], v[72:75], v[184:187], v[32:47]
  ds_read_b128 v[72:75], v7 offset:22528
  v_exp_f32 v82, v82
  v_exp_f32 v83, v83
  s_waitcnt lgkmcnt(7)
  v_mfma_f32_32x32x16_bf16 v[32:47], v[76:79], v[188:191], v[32:47]
  ds_read_b128 v[76:79], v7 offset:23552
  v_exp_f32 v84, v84
  v_exp_f32 v85, v85
  s_waitcnt lgkmcnt(7)
  v_mfma_f32_32x32x16_bf16 v[32:47], v[48:51], v[192:195], v[32:47]
  ds_read_b128 v[48:51], v7 offset:24576
  v_exp_f32 v86, v86
  v_exp_f32 v87, v87
  s_waitcnt lgkmcnt(7)
  v_mfma_f32_32x32x16_bf16 v[32:47], v[52:55], v[196:199], v[32:47]
  ds_read_b128 v[52:55], v7 offset:25600
  v_mul_f32 v112, v112, v120
  v_mul_f32 v113, v113, v121
  v_mul_f32 v114, v114, v122
  v_mul_f32 v115, v115, v123
  s_waitcnt lgkmcnt(7)
  v_mfma_f32_32x32x16_bf16 v[32:47], v[56:59], v[200:203], v[32:47]
  ds_read_b128 v[56:59], v7 offset:26624
  v_mul_f32 v116, v116, v124
  v_mul_f32 v117, v117, v125
  v_mul_f32 v118, v118, v126
  v_mul_f32 v119, v119, v127
  s_waitcnt lgkmcnt(7)
  v_mfma_f32_32x32x16_bf16 v[32:47], v[60:63], v[204:207], v[32:47]
  ds_read_b128 v[60:63], v7 offset:27648
  v_add_f32 v80, 1.0, v80
  v_add_f32 v81, 1.0, v81
  v_add_f32 v82, 1.0, v82
  v_add_f32 v83, 1.0, v83
  s_waitcnt lgkmcnt(7)
  v_mfma_f32_32x32x16_bf16 v[32:47], v[64:67], v[208:211], v[32:47]
  ds_read_b128 v[64:67], v7 offset:28672
  v_add_f32 v84, 1.0, v84
  v_add_f32 v85, 1.0, v85
  v_add_f32 v86, 1.0, v86
  v_add_f32 v87, 1.0, v87
  s_waitcnt lgkmcnt(7)
  v_mfma_f32_32x32x16_bf16 v[32:47], v[68:71], v[212:215], v[32:47]
  ds_read_b128 v[68:71], v7 offset:29696
  v_rcp_f32 v80, v80
  v_rcp_f32 v81, v81
  s_waitcnt lgkmcnt(7)
  v_mfma_f32_32x32x16_bf16 v[32:47], v[72:75], v[216:219], v[32:47]
  ds_read_b128 v[72:75], v7 offset:30720
  v_rcp_f32 v82, v82
  v_rcp_f32 v83, v83
  s_waitcnt lgkmcnt(7)
  v_mfma_f32_32x32x16_bf16 v[32:47], v[76:79], v[220:223], v[32:47]
  ds_read_b128 v[76:79], v7 offset:31744
  v_add_u32 v7, 32768, v7
  v_and_b32 v7, 0x1ffff, v7
  v_rcp_f32 v84, v84
  s_waitcnt lgkmcnt(7)
  v_mfma_f32_32x32x16_bf16 v[32:47], v[48:51], v[224:227], v[32:47]
  ds_read_b128 v[48:51], v7 offset:0
  v_rcp_f32 v85, v85
  v_rcp_f32 v86, v86
  s_waitcnt lgkmcnt(7)
  v_mfma_f32_32x32x16_bf16 v[32:47], v[52:55], v[228:231], v[32:47]
  ds_read_b128 v[52:55], v7 offset:1024
  v_rcp_f32 v87, v87
  v_mul_f32 v112, v112, v80
  v_mul_f32 v113, v113, v81
  s_waitcnt lgkmcnt(7)
  v_mfma_f32_32x32x16_bf16 v[32:47], v[56:59], v[232:235], v[32:47]
  ds_read_b128 v[56:59], v7 offset:2048
  v_mul_f32 v114, v114, v82
  v_mul_f32 v115, v115, v83
  v_mul_f32 v116, v116, v84
  v_mul_f32 v117, v117, v85
  s_waitcnt lgkmcnt(7)
  v_mfma_f32_32x32x16_bf16 v[32:47], v[60:63], v[236:239], v[32:47]
  ds_read_b128 v[60:63], v7 offset:3072
  v_mul_f32 v118, v118, v86
  v_mul_f32 v119, v119, v87
  v_cvt_pk_bf16_f32 v120, v112, v113
  v_cvt_pk_bf16_f32 v121, v114, v115
  s_waitcnt lgkmcnt(7)
  v_mfma_f32_32x32x16_bf16 v[32:47], v[64:67], v[240:243], v[32:47]
  ds_read_b128 v[64:67], v7 offset:4096
  v_cvt_pk_bf16_f32 v122, v116, v117
  v_cvt_pk_bf16_f32 v123, v118, v119
  buffer_store_dwordx4 v[120:123], v2, s[4:7], s29 offen sc1
  s_add_u32 s29, s29, 1024
  s_waitcnt lgkmcnt(7)
  v_mfma_f32_32x32x16_bf16 v[32:47], v[68:71], v[244:247], v[32:47]
  ds_read_b128 v[68:71], v7 offset:5120
  s_waitcnt lgkmcnt(7)
  v_mfma_f32_32x32x16_bf16 v[32:47], v[72:75], v[248:251], v[32:47]
  ds_read_b128 v[72:75], v7 offset:6144
  s_waitcnt lgkmcnt(7)
  v_mfma_f32_32x32x16_bf16 v[32:47], v[76:79], v[252:255], v[32:47]
  ds_read_b128 v[76:79], v7 offset:7168
  s_barrier
adaLN_cond__grouped_kv_mqa__glu_gated_swiglu__prompt_kernel_p5mid:
  ds_read_b64 v[8:9], v11
  ds_read_b128 v[80:83], v10 offset:0
  ds_read_b128 v[84:87], v10 offset:16
  ds_read_b128 v[88:91], v10 offset:32
  ds_read_b128 v[92:95], v10 offset:48
  ds_read_b128 v[96:99], v10 offset:128
  ds_read_b128 v[100:103], v10 offset:144
  ds_read_b128 v[104:107], v10 offset:160
  ds_read_b128 v[108:111], v10 offset:176
  v_add_u32 v10, 256, v10
  s_waitcnt lgkmcnt(15)
  v_mfma_f32_32x32x16_bf16 v[16:31], v[48:51], v[128:131], 0
  ds_read_b128 v[48:51], v7 offset:8192
  s_waitcnt lgkmcnt(15)
  v_mfma_f32_32x32x16_bf16 v[16:31], v[52:55], v[132:135], v[16:31]
  ds_read_b128 v[52:55], v7 offset:9216
  s_waitcnt lgkmcnt(15)
  v_mfma_f32_32x32x16_bf16 v[16:31], v[56:59], v[136:139], v[16:31]
  ds_read_b128 v[56:59], v7 offset:10240
  s_waitcnt lgkmcnt(3)
  v_mfma_f32_32x32x16_bf16 v[16:31], v[60:63], v[140:143], v[16:31]
  ds_read_b128 v[60:63], v7 offset:11264
  v_fma_f32 v96, -v9, v80, v96
  v_fma_f32 v97, -v9, v81, v97
  v_fma_f32 v98, -v9, v82, v98
  v_fma_f32 v99, -v9, v83, v99
  s_waitcnt lgkmcnt(7)
  v_mfma_f32_32x32x16_bf16 v[16:31], v[64:67], v[144:147], v[16:31]
  ds_read_b128 v[64:67], v7 offset:12288
  v_fma_f32 v100, -v9, v84, v100
  v_fma_f32 v101, -v9, v85, v101
  v_fma_f32 v102, -v9, v86, v102
  v_fma_f32 v103, -v9, v87, v103
  s_waitcnt lgkmcnt(7)
  v_mfma_f32_32x32x16_bf16 v[16:31], v[68:71], v[148:151], v[16:31]
  ds_read_b128 v[68:71], v7 offset:13312
  v_fma_f32 v104, -v9, v88, v104
  v_fma_f32 v105, -v9, v89, v105
  v_fma_f32 v106, -v9, v90, v106
  v_fma_f32 v107, -v9, v91, v107
  s_waitcnt lgkmcnt(7)
  v_mfma_f32_32x32x16_bf16 v[16:31], v[72:75], v[152:155], v[16:31]
  ds_read_b128 v[72:75], v7 offset:14336
  v_fma_f32 v108, -v9, v92, v108
  v_fma_f32 v109, -v9, v93, v109
  v_fma_f32 v110, -v9, v94, v110
  v_fma_f32 v111, -v9, v95, v111
  s_waitcnt lgkmcnt(7)
  v_mfma_f32_32x32x16_bf16 v[16:31], v[76:79], v[156:159], v[16:31]
  ds_read_b128 v[76:79], v7 offset:15360
  v_fma_f32 v112, v32, v8, v96
  v_fma_f32 v113, v33, v8, v97
  v_fma_f32 v114, v34, v8, v98
  v_fma_f32 v115, v35, v8, v99
  s_waitcnt lgkmcnt(7)
  v_mfma_f32_32x32x16_bf16 v[16:31], v[48:51], v[160:163], v[16:31]
  ds_read_b128 v[48:51], v7 offset:16384
  v_fma_f32 v116, v36, v8, v100
  v_fma_f32 v117, v37, v8, v101
  v_fma_f32 v118, v38, v8, v102
  v_fma_f32 v119, v39, v8, v103
  s_waitcnt lgkmcnt(7)
  v_mfma_f32_32x32x16_bf16 v[16:31], v[52:55], v[164:167], v[16:31]
  ds_read_b128 v[52:55], v7 offset:17408
  v_fma_f32 v120, v40, v8, v104
  v_fma_f32 v121, v41, v8, v105
  v_fma_f32 v122, v42, v8, v106
  v_fma_f32 v123, v43, v8, v107
  s_waitcnt lgkmcnt(7)
  v_mfma_f32_32x32x16_bf16 v[16:31], v[56:59], v[168:171], v[16:31]
  ds_read_b128 v[56:59], v7 offset:18432
  v_fma_f32 v124, v44, v8, v108
  v_fma_f32 v125, v45, v8, v109
  v_fma_f32 v126, v46, v8, v110
  v_fma_f32 v127, v47, v8, v111
  s_waitcnt lgkmcnt(7)
  v_mfma_f32_32x32x16_bf16 v[16:31], v[60:63], v[172:175], v[16:31]
  ds_read_b128 v[60:63], v7 offset:19456
  v_mul_f32 v80, 0xbfb8aa3b, v112
  v_mul_f32 v81, 0xbfb8aa3b, v113
  v_mul_f32 v82, 0xbfb8aa3b, v114
  v_mul_f32 v83, 0xbfb8aa3b, v115
  s_waitcnt lgkmcnt(7)
  v_mfma_f32_32x32x16_bf16 v[16:31], v[64:67], v[176:179], v[16:31]
  ds_read_b128 v[64:67], v7 offset:20480
  v_mul_f32 v84, 0xbfb8aa3b, v116
  v_mul_f32 v85, 0xbfb8aa3b, v117
  v_mul_f32 v86, 0xbfb8aa3b, v118
  v_mul_f32 v87, 0xbfb8aa3b, v119
  s_waitcnt lgkmcnt(7)
  v_mfma_f32_32x32x16_bf16 v[16:31], v[68:71], v[180:183], v[16:31]
  ds_read_b128 v[68:71], v7 offset:21504
  v_exp_f32 v80, v80
  v_exp_f32 v81, v81
  s_waitcnt lgkmcnt(7)
  v_mfma_f32_32x32x16_bf16 v[16:31], v[72:75], v[184:187], v[16:31]
  ds_read_b128 v[72:75], v7 offset:22528
  v_exp_f32 v82, v82
  v_exp_f32 v83, v83
  s_waitcnt lgkmcnt(7)
  v_mfma_f32_32x32x16_bf16 v[16:31], v[76:79], v[188:191], v[16:31]
  ds_read_b128 v[76:79], v7 offset:23552
  v_exp_f32 v84, v84
  v_exp_f32 v85, v85
  s_waitcnt lgkmcnt(7)
  v_mfma_f32_32x32x16_bf16 v[16:31], v[48:51], v[192:195], v[16:31]
  ds_read_b128 v[48:51], v7 offset:24576
  v_exp_f32 v86, v86
  v_exp_f32 v87, v87
  s_waitcnt lgkmcnt(7)
  v_mfma_f32_32x32x16_bf16 v[16:31], v[52:55], v[196:199], v[16:31]
  ds_read_b128 v[52:55], v7 offset:25600
  v_mul_f32 v112, v112, v120
  v_mul_f32 v113, v113, v121
  v_mul_f32 v114, v114, v122
  v_mul_f32 v115, v115, v123
  s_waitcnt lgkmcnt(7)
  v_mfma_f32_32x32x16_bf16 v[16:31], v[56:59], v[200:203], v[16:31]
  ds_read_b128 v[56:59], v7 offset:26624
  v_mul_f32 v116, v116, v124
  v_mul_f32 v117, v117, v125
  v_mul_f32 v118, v118, v126
  v_mul_f32 v119, v119, v127
  s_waitcnt lgkmcnt(7)
  v_mfma_f32_32x32x16_bf16 v[16:31], v[60:63], v[204:207], v[16:31]
  ds_read_b128 v[60:63], v7 offset:27648
  v_add_f32 v80, 1.0, v80
  v_add_f32 v81, 1.0, v81
  v_add_f32 v82, 1.0, v82
  v_add_f32 v83, 1.0, v83
  s_waitcnt lgkmcnt(7)
  v_mfma_f32_32x32x16_bf16 v[16:31], v[64:67], v[208:211], v[16:31]
  ds_read_b128 v[64:67], v7 offset:28672
  v_add_f32 v84, 1.0, v84
  v_add_f32 v85, 1.0, v85
  v_add_f32 v86, 1.0, v86
  v_add_f32 v87, 1.0, v87
  s_waitcnt lgkmcnt(7)
  v_mfma_f32_32x32x16_bf16 v[16:31], v[68:71], v[212:215], v[16:31]
  ds_read_b128 v[68:71], v7 offset:29696
  v_rcp_f32 v80, v80
  v_rcp_f32 v81, v81
  s_waitcnt lgkmcnt(7)
  v_mfma_f32_32x32x16_bf16 v[16:31], v[72:75], v[216:219], v[16:31]
  ds_read_b128 v[72:75], v7 offset:30720
  v_rcp_f32 v82, v82
  v_rcp_f32 v83, v83
  s_waitcnt lgkmcnt(7)
  v_mfma_f32_32x32x16_bf16 v[16:31], v[76:79], v[220:223], v[16:31]
  ds_read_b128 v[76:79], v7 offset:31744
  v_add_u32 v7, 32768, v7
  v_and_b32 v7, 0x1ffff, v7
  v_rcp_f32 v84, v84
  s_waitcnt lgkmcnt(7)
  v_mfma_f32_32x32x16_bf16 v[16:31], v[48:51], v[224:227], v[16:31]
  ds_read_b128 v[48:51], v7 offset:0
  v_rcp_f32 v85, v85
  v_rcp_f32 v86, v86
  s_waitcnt lgkmcnt(7)
  v_mfma_f32_32x32x16_bf16 v[16:31], v[52:55], v[228:231], v[16:31]
  ds_read_b128 v[52:55], v7 offset:1024
  v_rcp_f32 v87, v87
  v_mul_f32 v112, v112, v80
  v_mul_f32 v113, v113, v81
  s_waitcnt lgkmcnt(7)
  v_mfma_f32_32x32x16_bf16 v[16:31], v[56:59], v[232:235], v[16:31]
  ds_read_b128 v[56:59], v7 offset:2048
  v_mul_f32 v114, v114, v82
  v_mul_f32 v115, v115, v83
  v_mul_f32 v116, v116, v84
  v_mul_f32 v117, v117, v85
  s_waitcnt lgkmcnt(7)
  v_mfma_f32_32x32x16_bf16 v[16:31], v[60:63], v[236:239], v[16:31]
  ds_read_b128 v[60:63], v7 offset:3072
  v_mul_f32 v118, v118, v86
  v_mul_f32 v119, v119, v87
  v_cvt_pk_bf16_f32 v120, v112, v113
  v_cvt_pk_bf16_f32 v121, v114, v115
  s_waitcnt lgkmcnt(7)
  v_mfma_f32_32x32x16_bf16 v[16:31], v[64:67], v[240:243], v[16:31]
  ds_read_b128 v[64:67], v7 offset:4096
  v_cvt_pk_bf16_f32 v122, v116, v117
  v_cvt_pk_bf16_f32 v123, v118, v119
  buffer_store_dwordx4 v[120:123], v2, s[4:7], s29 offen sc1
  s_add_u32 s29, s29, 1024
  s_waitcnt lgkmcnt(7)
  v_mfma_f32_32x32x16_bf16 v[16:31], v[68:71], v[244:247], v[16:31]
  ds_read_b128 v[68:71], v7 offset:5120
  s_waitcnt lgkmcnt(7)
  v_mfma_f32_32x32x16_bf16 v[16:31], v[72:75], v[248:251], v[16:31]
  ds_read_b128 v[72:75], v7 offset:6144
  s_waitcnt lgkmcnt(7)
  v_mfma_f32_32x32x16_bf16 v[16:31], v[76:79], v[252:255], v[16:31]
  ds_read_b128 v[76:79], v7 offset:7168
  s_barrier
  s_add_u32 s30, s30, 1
  s_cmp_lt_u32 s30, 3
  s_cbranch_scc1 adaLN_cond__grouped_kv_mqa__glu_gated_swiglu__prompt_kernel_p5loop
  ds_read_b128 v[80:83], v10 offset:0
  ds_read_b128 v[84:87], v10 offset:16
  ds_read_b128 v[88:91], v10 offset:32
  ds_read_b128 v[92:95], v10 offset:48
  ds_read_b128 v[96:99], v10 offset:128
  ds_read_b128 v[100:103], v10 offset:144
  ds_read_b128 v[104:107], v10 offset:160
  ds_read_b128 v[108:111], v10 offset:176
  v_add_u32 v10, 256, v10
  s_waitcnt lgkmcnt(0)
  v_fma_f32 v96, -v9, v80, v96
  v_fma_f32 v97, -v9, v81, v97
  v_fma_f32 v98, -v9, v82, v98
  v_fma_f32 v99, -v9, v83, v99
  v_fma_f32 v100, -v9, v84, v100
  v_fma_f32 v101, -v9, v85, v101
  v_fma_f32 v102, -v9, v86, v102
  v_fma_f32 v103, -v9, v87, v103
  v_fma_f32 v104, -v9, v88, v104
  v_fma_f32 v105, -v9, v89, v105
  v_fma_f32 v106, -v9, v90, v106
  v_fma_f32 v107, -v9, v91, v107
  v_fma_f32 v108, -v9, v92, v108
  v_fma_f32 v109, -v9, v93, v109
  v_fma_f32 v110, -v9, v94, v110
  v_fma_f32 v111, -v9, v95, v111
  v_fma_f32 v112, v16, v8, v96
  v_fma_f32 v113, v17, v8, v97
  v_fma_f32 v114, v18, v8, v98
  v_fma_f32 v115, v19, v8, v99
  v_fma_f32 v116, v20, v8, v100
  v_fma_f32 v117, v21, v8, v101
  v_fma_f32 v118, v22, v8, v102
  v_fma_f32 v119, v23, v8, v103
  v_fma_f32 v120, v24, v8, v104
  v_fma_f32 v121, v25, v8, v105
  v_fma_f32 v122, v26, v8, v106
  v_fma_f32 v123, v27, v8, v107
  v_fma_f32 v124, v28, v8, v108
  v_fma_f32 v125, v29, v8, v109
  v_fma_f32 v126, v30, v8, v110
  v_fma_f32 v127, v31, v8, v111
  v_mul_f32 v80, 0xbfb8aa3b, v112
  v_mul_f32 v81, 0xbfb8aa3b, v113
  v_mul_f32 v82, 0xbfb8aa3b, v114
  v_mul_f32 v83, 0xbfb8aa3b, v115
  v_mul_f32 v84, 0xbfb8aa3b, v116
  v_mul_f32 v85, 0xbfb8aa3b, v117
  v_mul_f32 v86, 0xbfb8aa3b, v118
  v_mul_f32 v87, 0xbfb8aa3b, v119
  v_exp_f32 v80, v80
  v_exp_f32 v81, v81
  v_exp_f32 v82, v82
  v_exp_f32 v83, v83
  v_exp_f32 v84, v84
  v_exp_f32 v85, v85
  v_exp_f32 v86, v86
  v_exp_f32 v87, v87
  v_mul_f32 v112, v112, v120
  v_mul_f32 v113, v113, v121
  v_mul_f32 v114, v114, v122
  v_mul_f32 v115, v115, v123
  v_mul_f32 v116, v116, v124
  v_mul_f32 v117, v117, v125
  v_mul_f32 v118, v118, v126
  v_mul_f32 v119, v119, v127
  v_add_f32 v80, 1.0, v80
  v_add_f32 v81, 1.0, v81
  v_add_f32 v82, 1.0, v82
  v_add_f32 v83, 1.0, v83
  v_add_f32 v84, 1.0, v84
  v_add_f32 v85, 1.0, v85
  v_add_f32 v86, 1.0, v86
  v_add_f32 v87, 1.0, v87
  v_rcp_f32 v80, v80
  v_rcp_f32 v81, v81
  v_rcp_f32 v82, v82
  v_rcp_f32 v83, v83
  v_rcp_f32 v84, v84
  v_rcp_f32 v85, v85
  v_rcp_f32 v86, v86
  v_rcp_f32 v87, v87
  v_mul_f32 v112, v112, v80
  v_mul_f32 v113, v113, v81
  v_mul_f32 v114, v114, v82
  v_mul_f32 v115, v115, v83
  v_mul_f32 v116, v116, v84
  v_mul_f32 v117, v117, v85
  v_mul_f32 v118, v118, v86
  v_mul_f32 v119, v119, v87
  v_cvt_pk_bf16_f32 v120, v112, v113
  v_cvt_pk_bf16_f32 v121, v114, v115
  v_cvt_pk_bf16_f32 v122, v116, v117
  v_cvt_pk_bf16_f32 v123, v118, v119
  buffer_store_dwordx4 v[120:123], v2, s[4:7], s29 offen sc1
  s_add_u32 s29, s29, 1024
  s_waitcnt vmcnt(0)
  s_barrier
  s_cmp_lg_u32 s3, 0
  s_cbranch_scc1 adaLN_cond__grouped_kv_mqa__glu_gated_swiglu__prompt_kernel_p6n0
  s_bfe_u32 s29, s2, 0x20001
  s_lshl_b32 s29, s29, 2
  s_lshr_b32 s21, s2, 6
  s_add_u32 s29, s29, s21
  s_lshl_b32 s21, s24, 5
  s_add_u32 s21, s21, s29
  s_lshl_b32 s21, s21, 2
  s_add_u32 s21, s21, 382976
  s_mov_b64 exec, 1
  v_lshlrev_b32 v8, 9, v1
  v_mov_b32 v9, s42
  buffer_store_dword v9, v8, s[4:7], s21 offen sc1
  s_mov_b64 exec, -1
adaLN_cond__grouped_kv_mqa__glu_gated_swiglu__prompt_kernel_p6n0:
  s_mul_i32 s34, s22, 229376
  s_mul_i32 s21, s18, 28672
  s_add_u32 s34, s34, s21
  s_add_u32 s34, s34, 7358464
  s_add_u32 s35, s34, 114688
  buffer_load_dwordx4 v[128:131], v2, s[4:7], s34 offen offset:0 sc1
  buffer_load_dwordx4 v[132:135], v2, s[4:7], s35 offen offset:0 sc1
  buffer_load_dwordx4 v[136:139], v2, s[4:7], s34 offen offset:1024 sc1
  buffer_load_dwordx4 v[140:143], v2, s[4:7], s35 offen offset:1024 sc1
  buffer_load_dwordx4 v[144:147], v2, s[4:7], s34 offen offset:2048 sc1
  buffer_load_dwordx4 v[148:151], v2, s[4:7], s35 offen offset:2048 sc1
  buffer_load_dwordx4 v[152:155], v2, s[4:7], s34 offen offset:3072 sc1
  buffer_load_dwordx4 v[156:159], v2, s[4:7], s35 offen offset:3072 sc1
  s_add_u32 s34, s34, 4096
  s_add_u32 s35, s35, 4096
  buffer_load_dwordx4 v[160:163], v2, s[4:7], s34 offen offset:0 sc1
  buffer_load_dwordx4 v[164:167], v2, s[4:7], s35 offen offset:0 sc1
  buffer_load_dwordx4 v[168:171], v2, s[4:7], s34 offen offset:1024 sc1
  buffer_load_dwordx4 v[172:175], v2, s[4:7], s35 offen offset:1024 sc1
  buffer_load_dwordx4 v[176:179], v2, s[4:7], s34 offen offset:2048 sc1
  buffer_load_dwordx4 v[180:183], v2, s[4:7], s35 offen offset:2048 sc1
  buffer_load_dwordx4 v[184:187], v2, s[4:7], s34 offen offset:3072 sc1
  buffer_load_dwordx4 v[188:191], v2, s[4:7], s35 offen offset:3072 sc1
  s_add_u32 s34, s34, 4096
  s_add_u32 s35, s35, 4096
  buffer_load_dwordx4 v[192:195], v2, s[4:7], s34 offen offset:0 sc1
  buffer_load_dwordx4 v[196:199], v2, s[4:7], s35 offen offset:0 sc1
  buffer_load_dwordx4 v[200:203], v2, s[4:7], s34 offen offset:1024 sc1
  buffer_load_dwordx4 v[204:207], v2, s[4:7], s35 offen offset:1024 sc1
  s_branch adaLN_cond__grouped_kv_mqa__glu_gated_swiglu__prompt_kernel_p6
adaLN_cond__grouped_kv_mqa__glu_gated_swiglu__prompt_kernel_ldr:
  v_lshlrev_b32 v8, 2, v1
  s_add_u32 s21, s25, s18
  s_lshl_b32 s21, s21, 11
  s_add_u32 s21, s21, 524288
  s_add_u32 s29, s21, 8192
  buffer_load_dword v16, v8, s[4:7], s21 offen offset:0 sc1
  buffer_load_dword v24, v8, s[4:7], s29 offen offset:0 sc1
  buffer_load_dword v17, v8, s[4:7], s21 offen offset:256 sc1
  buffer_load_dword v25, v8, s[4:7], s29 offen offset:256 sc1
  buffer_load_dword v18, v8, s[4:7], s21 offen offset:512 sc1
  buffer_load_dword v26, v8, s[4:7], s29 offen offset:512 sc1
  buffer_load_dword v19, v8, s[4:7], s21 offen offset:768 sc1
  buffer_load_dword v27, v8, s[4:7], s29 offen offset:768 sc1
  buffer_load_dword v20, v8, s[4:7], s21 offen offset:1024 sc1
  buffer_load_dword v28, v8, s[4:7], s29 offen offset:1024 sc1
  buffer_load_dword v21, v8, s[4:7], s21 offen offset:1280 sc1
  buffer_load_dword v29, v8, s[4:7], s29 offen offset:1280 sc1
  buffer_load_dword v22, v8, s[4:7], s21 offen offset:1536 sc1
  buffer_load_dword v30, v8, s[4:7], s29 offen offset:1536 sc1
  buffer_load_dword v23, v8, s[4:7], s21 offen offset:1792 sc1
  buffer_load_dword v31, v8, s[4:7], s29 offen offset:1792 sc1
  s_add_u32 m0, s27, 65536
  s_nop 0
  buffer_load_dwordx4 v2, s[4:7], s26 offen offset:0 sc1 lds
  buffer_load_dwordx4 v2, s[4:7], s26 offen offset:1024 sc1 lds
  buffer_load_dwordx4 v2, s[4:7], s26 offen offset:2048 sc1 lds
  buffer_load_dwordx4 v2, s[4:7], s26 offen offset:3072 sc1 lds
  s_add_u32 s26, s26, 4096
  s_add_u32 m0, s27, 69632
  s_nop 0
  buffer_load_dwordx4 v2, s[4:7], s26 offen offset:0 sc1 lds
  buffer_load_dwordx4 v2, s[4:7], s26 offen offset:1024 sc1 lds
  buffer_load_dwordx4 v2, s[4:7], s26 offen offset:2048 sc1 lds
  buffer_load_dwordx4 v2, s[4:7], s26 offen offset:3072 sc1 lds
  s_add_u32 s26, s26, 28672
  s_add_u32 m0, s27, 98304
  s_nop 0
  buffer_load_dwordx4 v2, s[4:7], s26 offen offset:0 sc1 lds
  buffer_load_dwordx4 v2, s[4:7], s26 offen offset:1024 sc1 lds
  buffer_load_dwordx4 v2, s[4:7], s26 offen offset:2048 sc1 lds
  buffer_load_dwordx4 v2, s[4:7], s26 offen offset:3072 sc1 lds
  s_add_u32 s26, s26, 4096
  s_add_u32 m0, s27, 102400
  s_nop 0
  buffer_load_dwordx4 v2, s[4:7], s26 offen offset:0 sc1 lds
  buffer_load_dwordx4 v2, s[4:7], s26 offen offset:1024 sc1 lds
  buffer_load_dwordx4 v2, s[4:7], s26 offen offset:2048 sc1 lds
  buffer_load_dwordx4 v2, s[4:7], s26 offen offset:3072 sc1 lds
  s_add_u32 s26, s26, 28672
  s_lshl_b32 s29, s18, 8
  s_add_u32 s29, s29, 147456
  v_add_u32 v8, s29, v8
  s_waitcnt vmcnt(16)
  v_add_f32 v16, v16, v20
  v_add_f32 v24, v24, v28
  v_add_f32 v17, v17, v21
  v_add_f32 v25, v25, v29
  v_add_f32 v18, v18, v22
  v_add_f32 v26, v26, v30
  v_add_f32 v19, v19, v23
  v_add_f32 v27, v27, v31
  v_add_f32 v16, v16, v18
  v_add_f32 v24, v24, v26
  v_add_f32 v17, v17, v19
  v_add_f32 v25, v25, v27
  v_add_f32 v16, v16, v17
  v_add_f32 v24, v24, v25
  ds_write_b32 v8, v16
  ds_write_b32 v8, v24 offset:1024
  s_lshl_b32 s29, s24, 2
  s_add_u32 s29, s29, s18
  s_lshl_b32 s21, s29, 13
  s_add_u32 s21, s21, 25165824
  v_lshlrev_b32 v8, 3, v4
  v_lshl_add_u32 v9, v3, 12, v8
  s_setprio 2
  s_barrier
  buffer_load_dwordx2 v[16:17], v9, s[4:7], s21 offen offset:0 sc1
  buffer_load_dwordx2 v[18:19], v9, s[4:7], s21 offen offset:256 sc1
  buffer_load_dwordx2 v[20:21], v9, s[4:7], s21 offen offset:512 sc1
  buffer_load_dwordx2 v[22:23], v9, s[4:7], s21 offen offset:768 sc1
  buffer_load_dwordx2 v[24:25], v9, s[4:7], s21 offen offset:1024 sc1
  buffer_load_dwordx2 v[26:27], v9, s[4:7], s21 offen offset:1280 sc1
  buffer_load_dwordx2 v[28:29], v9, s[4:7], s21 offen offset:1536 sc1
  buffer_load_dwordx2 v[30:31], v9, s[4:7], s21 offen offset:1792 sc1
  buffer_load_dwordx2 v[32:33], v9, s[4:7], s21 offen offset:2048 sc1
  buffer_load_dwordx2 v[34:35], v9, s[4:7], s21 offen offset:2304 sc1
  buffer_load_dwordx2 v[36:37], v9, s[4:7], s21 offen offset:2560 sc1
  buffer_load_dwordx2 v[38:39], v9, s[4:7], s21 offen offset:2816 sc1
  buffer_load_dwordx2 v[40:41], v9, s[4:7], s21 offen offset:3072 sc1
  buffer_load_dwordx2 v[42:43], v9, s[4:7], s21 offen offset:3328 sc1
  buffer_load_dwordx2 v[44:45], v9, s[4:7], s21 offen offset:3584 sc1
  buffer_load_dwordx2 v[46:47], v9, s[4:7], s21 offen offset:3840 sc1
  s_lshl_b32 s29, s18, 8
  s_add_u32 s29, s29, 149504
  v_add_u32 v8, s29, v8
  s_waitcnt vmcnt(0)
  v_add_f32 v16, v16, v32
  v_add_f32 v17, v17, v33
  v_add_f32 v18, v18, v34
  v_add_f32 v19, v19, v35
  v_add_f32 v20, v20, v36
  v_add_f32 v21, v21, v37
  v_add_f32 v22, v22, v38
  v_add_f32 v23, v23, v39
  v_add_f32 v24, v24, v40
  v_add_f32 v25, v25, v41
  v_add_f32 v26, v26, v42
  v_add_f32 v27, v27, v43
  v_add_f32 v28, v28, v44
  v_add_f32 v29, v29, v45
  v_add_f32 v30, v30, v46
  v_add_f32 v31, v31, v47
  v_add_f32 v16, v16, v24
  v_add_f32 v17, v17, v25
  v_add_f32 v18, v18, v26
  v_add_f32 v19, v19, v27
  v_add_f32 v20, v20, v28
  v_add_f32 v21, v21, v29
  v_add_f32 v22, v22, v30
  v_add_f32 v23, v23, v31
  v_add_f32 v16, v16, v20
  v_add_f32 v17, v17, v21
  v_add_f32 v18, v18, v22
  v_add_f32 v19, v19, v23
  v_add_f32 v16, v16, v18
  v_add_f32 v17, v17, v19
  v_mov_b32 v18, v16
  v_mov_b32 v19, v17
  s_nop 1
  v_permlane32_swap_b32 v16, v18
  v_permlane32_swap_b32 v17, v19
  v_add_f32 v16, v16, v18
  v_add_f32 v17, v17, v19
  v_mul_f32 v16, 0x3b000000, v16
  v_mul_f32 v17, 0x3b000000, v17
  v_fma_f32 v17, -v16, v16, v17
  v_max_f32 v17, 0, v17
  v_add_f32 v17, 0x3727c5ac, v17
  v_rsq_f32 v18, v17
  s_nop 0
  v_mul_f32 v19, v16, v18
  ds_write_b64 v8, v[18:19]
  s_setprio 0
  s_waitcnt lgkmcnt(0)
  s_barrier
  s_add_u32 m0, s27, 0
  s_nop 0
  buffer_load_dwordx4 v2, s[4:7], s26 offen offset:0 sc1 lds
  buffer_load_dwordx4 v2, s[4:7], s26 offen offset:1024 sc1 lds
  buffer_load_dwordx4 v2, s[4:7], s26 offen offset:2048 sc1 lds
  buffer_load_dwordx4 v2, s[4:7], s26 offen offset:3072 sc1 lds
  s_add_u32 s26, s26, 4096
  s_add_u32 m0, s27, 4096
  s_nop 0
  buffer_load_dwordx4 v2, s[4:7], s26 offen offset:0 sc1 lds
  buffer_load_dwordx4 v2, s[4:7], s26 offen offset:1024 sc1 lds
  buffer_load_dwordx4 v2, s[4:7], s26 offen offset:2048 sc1 lds
  buffer_load_dwordx4 v2, s[4:7], s26 offen offset:3072 sc1 lds
  s_add_u32 s26, s26, 28672
  s_add_u32 m0, s27, 32768
  s_nop 0
  buffer_load_dwordx4 v2, s[4:7], s26 offen offset:0 sc1 lds
  buffer_load_dwordx4 v2, s[4:7], s26 offen offset:1024 sc1 lds
  buffer_load_dwordx4 v2, s[4:7], s26 offen offset:2048 sc1 lds
  buffer_load_dwordx4 v2, s[4:7], s26 offen offset:3072 sc1 lds
  s_add_u32 s26, s26, 4096
  s_add_u32 m0, s27, 36864
  s_nop 0
  buffer_load_dwordx4 v2, s[4:7], s26 offen offset:0 sc1 lds
  buffer_load_dwordx4 v2, s[4:7], s26 offen offset:1024 sc1 lds
  buffer_load_dwordx4 v2, s[4:7], s26 offen offset:2048 sc1 lds
  buffer_load_dwordx4 v2, s[4:7], s26 offen offset:3072 sc1 lds
  s_add_u32 s26, s26, 28672
  s_waitcnt vmcnt(8)
  s_barrier
  s_add_u32 m0, s27, 65536
  s_nop 0
  buffer_load_dwordx4 v2, s[4:7], s26 offen offset:0 sc1 lds
  buffer_load_dwordx4 v2, s[4:7], s26 offen offset:1024 sc1 lds
  buffer_load_dwordx4 v2, s[4:7], s26 offen offset:2048 sc1 lds
  buffer_load_dwordx4 v2, s[4:7], s26 offen offset:3072 sc1 lds
  s_add_u32 s26, s26, 4096
  s_add_u32 m0, s27, 69632
  s_nop 0
  buffer_load_dwordx4 v2, s[4:7], s26 offen offset:0 sc1 lds
  buffer_load_dwordx4 v2, s[4:7], s26 offen offset:1024 sc1 lds
  buffer_load_dwordx4 v2, s[4:7], s26 offen offset:2048 sc1 lds
  buffer_load_dwordx4 v2, s[4:7], s26 offen offset:3072 sc1 lds
  s_add_u32 s26, s26, 28672
  s_mul_i32 s26, s22, 229376
  s_mul_i32 s21, s18, 28672
  s_add_u32 s26, s26, s21
  s_add_u32 s26, s26, 7340032
  s_add_u32 s25, s26, 114688
  s_mul_i32 s21, s18, 4096
  s_add_u32 s21, s21, 131072
  s_add_u32 m0, s21, 0
  s_nop 0
  buffer_load_dwordx4 v2, s[4:7], s26 offen sc1 lds
  s_add_u32 s26, s26, 1024
  s_add_u32 m0, s21, 1024
  s_nop 0
  buffer_load_dwordx4 v2, s[4:7], s25 offen sc1 lds
  s_add_u32 s25, s25, 1024
  s_add_u32 m0, s21, 2048
  s_nop 0
  buffer_load_dwordx4 v2, s[4:7], s26 offen sc1 lds
  s_add_u32 s26, s26, 1024
  s_add_u32 m0, s21, 3072
  s_nop 0
  buffer_load_dwordx4 v2, s[4:7], s25 offen sc1 lds
  s_add_u32 s25, s25, 1024
  s_waitcnt vmcnt(12)
  s_barrier
  s_mul_i32 s21, s18, 8192
  s_add_u32 s21, s21, 98304
  s_add_u32 m0, s21, 0
  s_nop 0
  buffer_load_dwordx4 v2, s[4:7], s26 offen sc1 lds
  s_add_u32 s26, s26, 1024
  s_add_u32 m0, s21, 1024
  s_nop 0
  buffer_load_dwordx4 v2, s[4:7], s25 offen sc1 lds
  s_add_u32 s25, s25, 1024
  s_add_u32 m0, s21, 2048
  s_nop 0
  buffer_load_dwordx4 v2, s[4:7], s26 offen sc1 lds
  s_add_u32 s26, s26, 1024
  s_add_u32 m0, s21, 3072
  s_nop 0
  buffer_load_dwordx4 v2, s[4:7], s25 offen sc1 lds
  s_add_u32 s25, s25, 1024
  s_add_u32 m0, s21, 4096
  s_nop 0
  buffer_load_dwordx4 v2, s[4:7], s26 offen sc1 lds
  s_add_u32 s26, s26, 1024
  s_add_u32 m0, s21, 5120
  s_nop 0
  buffer_load_dwordx4 v2, s[4:7], s25 offen sc1 lds
  s_add_u32 s25, s25, 1024
  s_add_u32 m0, s21, 6144
  s_nop 0
  buffer_load_dwordx4 v2, s[4:7], s26 offen sc1 lds
  s_add_u32 s26, s26, 1024
  s_add_u32 m0, s21, 7168
  s_nop 0
  buffer_load_dwordx4 v2, s[4:7], s25 offen sc1 lds
  s_add_u32 s25, s25, 1024
  s_mul_i32 s34, s22, 229376
  s_mul_i32 s21, s18, 28672
  s_add_u32 s34, s34, s21
  s_add_u32 s34, s34, 7358464
  s_add_u32 s35, s34, 114688
  buffer_load_dwordx4 v[128:131], v2, s[4:7], s34 offen offset:0 sc1
  buffer_load_dwordx4 v[132:135], v2, s[4:7], s35 offen offset:0 sc1
  buffer_load_dwordx4 v[136:139], v2, s[4:7], s34 offen offset:1024 sc1
  buffer_load_dwordx4 v[140:143], v2, s[4:7], s35 offen offset:1024 sc1
  buffer_load_dwordx4 v[144:147], v2, s[4:7], s34 offen offset:2048 sc1
  buffer_load_dwordx4 v[148:151], v2, s[4:7], s35 offen offset:2048 sc1
  s_waitcnt vmcnt(18)
  s_barrier
  s_mul_i32 s21, s18, 8192
  s_add_u32 s21, s21, 0
  s_add_u32 m0, s21, 0
  s_nop 0
  buffer_load_dwordx4 v2, s[4:7], s26 offen sc1 lds
  s_add_u32 s26, s26, 1024
  s_add_u32 m0, s21, 1024
  s_nop 0
  buffer_load_dwordx4 v2, s[4:7], s25 offen sc1 lds
  s_add_u32 s25, s25, 1024
  s_add_u32 m0, s21, 2048
  s_nop 0
  buffer_load_dwordx4 v2, s[4:7], s26 offen sc1 lds
  s_add_u32 s26, s26, 1024
  s_add_u32 m0, s21, 3072
  s_nop 0
  buffer_load_dwordx4 v2, s[4:7], s25 offen sc1 lds
  s_add_u32 s25, s25, 1024
  s_add_u32 m0, s21, 4096
  s_nop 0
  buffer_load_dwordx4 v2, s[4:7], s26 offen sc1 lds
  s_add_u32 s26, s26, 1024
  s_add_u32 m0, s21, 5120
  s_nop 0
  buffer_load_dwordx4 v2, s[4:7], s25 offen sc1 lds
  s_add_u32 s25, s25, 1024
  s_add_u32 m0, s21, 6144
  s_nop 0
  buffer_load_dwordx4 v2, s[4:7], s26 offen sc1 lds
  s_add_u32 s26, s26, 1024
  s_add_u32 m0, s21, 7168
  s_nop 0
  buffer_load_dwordx4 v2, s[4:7], s25 offen sc1 lds
  s_add_u32 s25, s25, 1024
  buffer_load_dwordx4 v[152:155], v2, s[4:7], s34 offen offset:3072 sc1
  buffer_load_dwordx4 v[156:159], v2, s[4:7], s35 offen offset:3072 sc1
  s_add_u32 s34, s34, 4096
  s_add_u32 s35, s35, 4096
  buffer_load_dwordx4 v[160:163], v2, s[4:7], s34 offen offset:0 sc1
  buffer_load_dwordx4 v[164:167], v2, s[4:7], s35 offen offset:0 sc1
  buffer_load_dwordx4 v[168:171], v2, s[4:7], s34 offen offset:1024 sc1
  buffer_load_dwordx4 v[172:175], v2, s[4:7], s35 offen offset:1024 sc1
  buffer_load_dwordx4 v[176:179], v2, s[4:7], s34 offen offset:2048 sc1
  buffer_load_dwordx4 v[180:183], v2, s[4:7], s35 offen offset:2048 sc1
  s_barrier
  s_mul_i32 s21, s18, 8192
  s_add_u32 s21, s21, 32768
  s_add_u32 m0, s21, 0
  s_nop 0
  buffer_load_dwordx4 v2, s[4:7], s26 offen sc1 lds
  s_add_u32 s26, s26, 1024
  s_add_u32 m0, s21, 1024
  s_nop 0
  buffer_load_dwordx4 v2, s[4:7], s25 offen sc1 lds
  s_add_u32 s25, s25, 1024
  s_add_u32 m0, s21, 2048
  s_nop 0
  buffer_load_dwordx4 v2, s[4:7], s26 offen sc1 lds
  s_add_u32 s26, s26, 1024
  s_add_u32 m0, s21, 3072
  s_nop 0
  buffer_load_dwordx4 v2, s[4:7], s25 offen sc1 lds
  s_add_u32 s25, s25, 1024
  s_add_u32 m0, s21, 4096
  s_nop 0
  buffer_load_dwordx4 v2, s[4:7], s26 offen sc1 lds
  s_add_u32 s26, s26, 1024
  s_add_u32 m0, s21, 5120
  s_nop 0
  buffer_load_dwordx4 v2, s[4:7], s25 offen sc1 lds
  s_add_u32 s25, s25, 1024
  s_add_u32 m0, s21, 6144
  s_nop 0
  buffer_load_dwordx4 v2, s[4:7], s26 offen sc1 lds
  s_add_u32 s26, s26, 1024
  s_add_u32 m0, s21, 7168
  s_nop 0
  buffer_load_dwordx4 v2, s[4:7], s25 offen sc1 lds
  s_add_u32 s25, s25, 1024
  buffer_load_dwordx4 v[184:187], v2, s[4:7], s34 offen offset:3072 sc1
  buffer_load_dwordx4 v[188:191], v2, s[4:7], s35 offen offset:3072 sc1
  s_add_u32 s34, s34, 4096
  s_add_u32 s35, s35, 4096
  buffer_load_dwordx4 v[192:195], v2, s[4:7], s34 offen offset:0 sc1
  buffer_load_dwordx4 v[196:199], v2, s[4:7], s35 offen offset:0 sc1
  buffer_load_dwordx4 v[200:203], v2, s[4:7], s34 offen offset:1024 sc1
  buffer_load_dwordx4 v[204:207], v2, s[4:7], s35 offen offset:1024 sc1
  s_barrier
  s_barrier
  s_mul_i32 s21, s18, 8192
  s_add_u32 s21, s21, 65536
  s_add_u32 m0, s21, 0
  s_nop 0
  buffer_load_dwordx4 v2, s[4:7], s26 offen sc1 lds
  s_add_u32 s26, s26, 1024
  s_add_u32 m0, s21, 1024
  s_nop 0
  buffer_load_dwordx4 v2, s[4:7], s25 offen sc1 lds
  s_add_u32 s25, s25, 1024
  s_add_u32 m0, s21, 2048
  s_nop 0
  buffer_load_dwordx4 v2, s[4:7], s26 offen sc1 lds
  s_add_u32 s26, s26, 1024
  s_add_u32 m0, s21, 3072
  s_nop 0
  buffer_load_dwordx4 v2, s[4:7], s25 offen sc1 lds
  s_add_u32 s25, s25, 1024
  s_add_u32 m0, s21, 4096
  s_nop 0
  buffer_load_dwordx4 v2, s[4:7], s26 offen sc1 lds
  s_add_u32 s26, s26, 1024
  s_add_u32 m0, s21, 5120
  s_nop 0
  buffer_load_dwordx4 v2, s[4:7], s25 offen sc1 lds
  s_add_u32 s25, s25, 1024
  s_add_u32 m0, s21, 6144
  s_nop 0
  buffer_load_dwordx4 v2, s[4:7], s26 offen sc1 lds
  s_add_u32 s26, s26, 1024
  s_add_u32 m0, s21, 7168
  s_nop 0
  buffer_load_dwordx4 v2, s[4:7], s25 offen sc1 lds
  s_add_u32 s25, s25, 1024
adaLN_cond__grouped_kv_mqa__glu_gated_swiglu__prompt_kernel_p6:
  s_cmp_lg_u32 s3, 0
  s_cbranch_scc1 adaLN_cond__grouped_kv_mqa__glu_gated_swiglu__prompt_kernel_p6np
  s_lshr_b32 s21, s19, 1
  s_lshl_b32 s21, s21, 7
  s_add_u32 s21, s21, 382976
  v_and_b32 v8, 15, v1
  v_lshlrev_b32 v8, 2, v8
  s_mov_b32 s30, 0
adaLN_cond__grouped_kv_mqa__glu_gated_swiglu__prompt_kernel_poll6:
  buffer_load_dword v9, v8, s[4:7], s21 offen offset:0 sc1
  s_add_u32 s30, s30, 1
  s_waitcnt vmcnt(0)
  v_cmp_ne_u32 vcc, s42, v9
  s_nop 1
  s_cbranch_vccz adaLN_cond__grouped_kv_mqa__glu_gated_swiglu__prompt_kernel_poll6d
  s_sleep 1
  s_cmp_lt_u32 s30, 0x20000
  s_cbranch_scc1 adaLN_cond__grouped_kv_mqa__glu_gated_swiglu__prompt_kernel_poll6
adaLN_cond__grouped_kv_mqa__glu_gated_swiglu__prompt_kernel_poll6d:
adaLN_cond__grouped_kv_mqa__glu_gated_swiglu__prompt_kernel_p6np:
  s_mul_i32 s21, s23, 114688
  s_mul_i32 s29, s18, 28672
  s_add_u32 s21, s21, s29
  s_add_u32 s21, s21, 17825792
  s_lshl_b32 s29, s18, 12
  s_add_u32 s29, s29, 131072
  v_add_u32 v8, s29, v2
  s_lshl_b32 s29, s18, 13
  v_add_u32 v9, s29, v2
  v_add_u32 v10, 65536, v9
  s_waitcnt vmcnt(0)
  s_barrier
  buffer_load_dwordx4 v[16:19], v2, s[4:7], s21 offen offset:0 sc1
  buffer_load_dwordx4 v[20:23], v2, s[4:7], s21 offen offset:1024 sc1
  buffer_load_dwordx4 v[24:27], v2, s[4:7], s21 offen offset:2048 sc1
  buffer_load_dwordx4 v[28:31], v2, s[4:7], s21 offen offset:3072 sc1
  s_add_u32 s21, s21, 4096
  buffer_load_dwordx4 v[32:35], v2, s[4:7], s21 offen offset:0 sc1
  buffer_load_dwordx4 v[36:39], v2, s[4:7], s21 offen offset:1024 sc1
  buffer_load_dwordx4 v[40:43], v2, s[4:7], s21 offen offset:2048 sc1
  buffer_load_dwordx4 v[44:47], v2, s[4:7], s21 offen offset:3072 sc1
  s_add_u32 s21, s21, 4096
  buffer_load_dwordx4 v[48:51], v2, s[4:7], s21 offen offset:0 sc1
  buffer_load_dwordx4 v[52:55], v2, s[4:7], s21 offen offset:1024 sc1
  ds_read_b128 v[240:243], v8 offset:0
  ds_read_b128 v[244:247], v8 offset:1024
  ds_read_b128 v[248:251], v8 offset:2048
  ds_read_b128 v[252:255], v8 offset:3072
  s_waitcnt vmcnt(9) lgkmcnt(2)
  v_mfma_f32_32x32x16_bf16 v[208:223], v[240:243], v[16:19], 0
  v_mfma_f32_32x32x16_bf16 v[224:239], v[244:247], v[16:19], 0
  ds_read_b128 v[240:243], v10 offset:32768
  ds_read_b128 v[244:247], v10 offset:33792
  buffer_load_dwordx4 v[56:59], v2, s[4:7], s21 offen offset:2048 sc1
  s_waitcnt vmcnt(9) lgkmcnt(2)
  v_mfma_f32_32x32x16_bf16 v[208:223], v[248:251], v[20:23], v[208:223]
  v_mfma_f32_32x32x16_bf16 v[224:239], v[252:255], v[20:23], v[224:239]
  ds_read_b128 v[248:251], v10 offset:34816
  ds_read_b128 v[252:255], v10 offset:35840
  buffer_load_dwordx4 v[60:63], v2, s[4:7], s21 offen offset:3072 sc1
  s_add_u32 s21, s21, 4096
  s_waitcnt vmcnt(9) lgkmcnt(2)
  v_mfma_f32_32x32x16_bf16 v[208:223], v[240:243], v[24:27], v[208:223]
  v_mfma_f32_32x32x16_bf16 v[224:239], v[244:247], v[24:27], v[224:239]
  ds_read_b128 v[240:243], v10 offset:36864
  ds_read_b128 v[244:247], v10 offset:37888
  buffer_load_dwordx4 v[64:67], v2, s[4:7], s21 offen offset:0 sc1
  s_waitcnt vmcnt(9) lgkmcnt(2)
  v_mfma_f32_32x32x16_bf16 v[208:223], v[248:251], v[28:31], v[208:223]
  v_mfma_f32_32x32x16_bf16 v[224:239], v[252:255], v[28:31], v[224:239]
  ds_read_b128 v[248:251], v10 offset:38912
  ds_read_b128 v[252:255], v10 offset:39936
  buffer_load_dwordx4 v[68:71], v2, s[4:7], s21 offen offset:1024 sc1
  s_waitcnt vmcnt(9) lgkmcnt(2)
  v_mfma_f32_32x32x16_bf16 v[208:223], v[240:243], v[32:35], v[208:223]
  v_mfma_f32_32x32x16_bf16 v[224:239], v[244:247], v[32:35], v[224:239]
  ds_read_b128 v[240:243], v9 offset:0
  ds_read_b128 v[244:247], v9 offset:1024
  buffer_load_dwordx4 v[72:75], v2, s[4:7], s21 offen offset:2048 sc1
  s_waitcnt vmcnt(9) lgkmcnt(2)
  v_mfma_f32_32x32x16_bf16 v[208:223], v[248:251], v[36:39], v[208:223]
  v_mfma_f32_32x32x16_bf16 v[224:239], v[252:255], v[36:39], v[224:239]
  ds_read_b128 v[248:251], v9 offset:2048
  ds_read_b128 v[252:255], v9 offset:3072
  buffer_load_dwordx4 v[76:79], v2, s[4:7], s21 offen offset:3072 sc1
  s_add_u32 s21, s21, 4096
  s_waitcnt vmcnt(9) lgkmcnt(2)
  v_mfma_f32_32x32x16_bf16 v[208:223], v[240:243], v[40:43], v[208:223]
  v_mfma_f32_32x32x16_bf16 v[224:239], v[244:247], v[40:43], v[224:239]
  ds_read_b128 v[240:243], v9 offset:4096
  ds_read_b128 v[244:247], v9 offset:5120
  buffer_load_dwordx4 v[80:83], v2, s[4:7], s21 offen offset:0 sc1
  s_waitcnt vmcnt(9) lgkmcnt(2)
  v_mfma_f32_32x32x16_bf16 v[208:223], v[248:251], v[44:47], v[208:223]
  v_mfma_f32_32x32x16_bf16 v[224:239], v[252:255], v[44:47], v[224:239]
  ds_read_b128 v[248:251], v9 offset:6144
  ds_read_b128 v[252:255], v9 offset:7168
  buffer_load_dwordx4 v[84:87], v2, s[4:7], s21 offen offset:1024 sc1
  s_waitcnt vmcnt(9) lgkmcnt(2)
  v_mfma_f32_32x32x16_bf16 v[208:223], v[240:243], v[48:51], v[208:223]
  v_mfma_f32_32x32x16_bf16 v[224:239], v[244:247], v[48:51], v[224:239]
  ds_read_b128 v[240:243], v9 offset:32768
  ds_read_b128 v[244:247], v9 offset:33792
  buffer_load_dwordx4 v[88:91], v2, s[4:7], s21 offen offset:2048 sc1
  s_waitcnt vmcnt(9) lgkmcnt(2)
  v_mfma_f32_32x32x16_bf16 v[208:223], v[248:251], v[52:55], v[208:223]
  v_mfma_f32_32x32x16_bf16 v[224:239], v[252:255], v[52:55], v[224:239]
  ds_read_b128 v[248:251], v9 offset:34816
  ds_read_b128 v[252:255], v9 offset:35840
  buffer_load_dwordx4 v[92:95], v2, s[4:7], s21 offen offset:3072 sc1
  s_add_u32 s21, s21, 4096
  s_waitcnt vmcnt(9) lgkmcnt(2)
  v_mfma_f32_32x32x16_bf16 v[208:223], v[240:243], v[56:59], v[208:223]
  v_mfma_f32_32x32x16_bf16 v[224:239], v[244:247], v[56:59], v[224:239]
  ds_read_b128 v[240:243], v9 offset:36864
  ds_read_b128 v[244:247], v9 offset:37888
  buffer_load_dwordx4 v[96:99], v2, s[4:7], s21 offen offset:0 sc1
  s_waitcnt vmcnt(9) lgkmcnt(2)
  v_mfma_f32_32x32x16_bf16 v[208:223], v[248:251], v[60:63], v[208:223]
  v_mfma_f32_32x32x16_bf16 v[224:239], v[252:255], v[60:63], v[224:239]
  ds_read_b128 v[248:251], v9 offset:38912
  ds_read_b128 v[252:255], v9 offset:39936
  buffer_load_dwordx4 v[100:103], v2, s[4:7], s21 offen offset:1024 sc1
  s_waitcnt vmcnt(9) lgkmcnt(2)
  v_mfma_f32_32x32x16_bf16 v[208:223], v[240:243], v[64:67], v[208:223]
  v_mfma_f32_32x32x16_bf16 v[224:239], v[244:247], v[64:67], v[224:239]
  ds_read_b128 v[240:243], v10 offset:0
  ds_read_b128 v[244:247], v10 offset:1024
  buffer_load_dwordx4 v[104:107], v2, s[4:7], s21 offen offset:2048 sc1
  s_waitcnt vmcnt(9) lgkmcnt(2)
  v_mfma_f32_32x32x16_bf16 v[208:223], v[248:251], v[68:71], v[208:223]
  v_mfma_f32_32x32x16_bf16 v[224:239], v[252:255], v[68:71], v[224:239]
  ds_read_b128 v[248:251], v10 offset:2048
  ds_read_b128 v[252:255], v10 offset:3072
  buffer_load_dwordx4 v[108:111], v2, s[4:7], s21 offen offset:3072 sc1
  s_add_u32 s21, s21, 4096
  s_waitcnt vmcnt(9) lgkmcnt(2)
  v_mfma_f32_32x32x16_bf16 v[208:223], v[240:243], v[72:75], v[208:223]
  v_mfma_f32_32x32x16_bf16 v[224:239], v[244:247], v[72:75], v[224:239]
  ds_read_b128 v[240:243], v10 offset:4096
  ds_read_b128 v[244:247], v10 offset:5120
  buffer_load_dwordx4 v[112:115], v2, s[4:7], s21 offen offset:0 sc1
  s_waitcnt vmcnt(9) lgkmcnt(2)
  v_mfma_f32_32x32x16_bf16 v[208:223], v[248:251], v[76:79], v[208:223]
  v_mfma_f32_32x32x16_bf16 v[224:239], v[252:255], v[76:79], v[224:239]
  ds_read_b128 v[248:251], v10 offset:6144
  ds_read_b128 v[252:255], v10 offset:7168
  buffer_load_dwordx4 v[116:119], v2, s[4:7], s21 offen offset:1024 sc1
  s_waitcnt vmcnt(9) lgkmcnt(2)
  v_mfma_f32_32x32x16_bf16 v[208:223], v[240:243], v[80:83], v[208:223]
  v_mfma_f32_32x32x16_bf16 v[224:239], v[244:247], v[80:83], v[224:239]
  buffer_load_dwordx4 v[120:123], v2, s[4:7], s21 offen offset:2048 sc1
  s_waitcnt vmcnt(9) lgkmcnt(0)
  v_mfma_f32_32x32x16_bf16 v[208:223], v[248:251], v[84:87], v[208:223]
  v_mfma_f32_32x32x16_bf16 v[224:239], v[252:255], v[84:87], v[224:239]
  buffer_load_dwordx4 v[124:127], v2, s[4:7], s21 offen offset:3072 sc1
  s_add_u32 s21, s21, 4096
  s_waitcnt vmcnt(9)
  v_mfma_f32_32x32x16_bf16 v[208:223], v[128:131], v[88:91], v[208:223]
  v_mfma_f32_32x32x16_bf16 v[224:239], v[132:135], v[88:91], v[224:239]
  s_lshl_b32 s29, s31, 6
  s_add_u32 s29, s29, 10240
  buffer_load_dwordx4 v[240:243], v5, s[4:7], s29 offen offset:0 sc1
  buffer_load_dwordx4 v[244:247], v5, s[4:7], s29 offen offset:32 sc1
  s_waitcnt vmcnt(10)
  v_mfma_f32_32x32x16_bf16 v[208:223], v[136:139], v[92:95], v[208:223]
  v_mfma_f32_32x32x16_bf16 v[224:239], v[140:143], v[92:95], v[224:239]
  s_waitcnt vmcnt(9)
  v_mfma_f32_32x32x16_bf16 v[208:223], v[144:147], v[96:99], v[208:223]
  v_mfma_f32_32x32x16_bf16 v[224:239], v[148:151], v[96:99], v[224:239]
  s_waitcnt vmcnt(8)
  v_mfma_f32_32x32x16_bf16 v[208:223], v[152:155], v[100:103], v[208:223]
  v_mfma_f32_32x32x16_bf16 v[224:239], v[156:159], v[100:103], v[224:239]
  s_waitcnt vmcnt(7)
  v_mfma_f32_32x32x16_bf16 v[208:223], v[160:163], v[104:107], v[208:223]
  v_mfma_f32_32x32x16_bf16 v[224:239], v[164:167], v[104:107], v[224:239]
  s_waitcnt vmcnt(6)
  v_mfma_f32_32x32x16_bf16 v[208:223], v[168:171], v[108:111], v[208:223]
  v_mfma_f32_32x32x16_bf16 v[224:239], v[172:175], v[108:111], v[224:239]
  s_waitcnt vmcnt(5)
  v_mfma_f32_32x32x16_bf16 v[208:223], v[176:179], v[112:115], v[208:223]
  v_mfma_f32_32x32x16_bf16 v[224:239], v[180:183], v[112:115], v[224:239]
  s_waitcnt vmcnt(4)
  v_mfma_f32_32x32x16_bf16 v[208:223], v[184:187], v[116:119], v[208:223]
  v_mfma_f32_32x32x16_bf16 v[224:239], v[188:191], v[116:119], v[224:239]
  s_waitcnt vmcnt(3)
  v_mfma_f32_32x32x16_bf16 v[208:223], v[192:195], v[120:123], v[208:223]
  v_mfma_f32_32x32x16_bf16 v[224:239], v[196:199], v[120:123], v[224:239]
  s_waitcnt vmcnt(2)
  v_mfma_f32_32x32x16_bf16 v[208:223], v[200:203], v[124:127], v[208:223]
  v_mfma_f32_32x32x16_bf16 v[224:239], v[204:207], v[124:127], v[224:239]
  s_barrier
  s_lshl_b32 s21, s20, 15
  s_lshl_b32 s29, s18, 11
  s_add_u32 s29, s29, s21
  s_add_u32 s29, s29, 0
  v_add_u32 v8, s29, v2
  s_lshl_b32 s29, s18, 13
  s_add_u32 s29, s29, s21
  s_add_u32 s29, s29, 0
  v_add_u32 v9, s29, v2
  s_nop 4
  ds_write_b128 v8, v[208:211] offset:0
  ds_write_b128 v8, v[212:215] offset:1024
  ds_write_b128 v8, v[216:219] offset:8192
  ds_write_b128 v8, v[220:223] offset:9216
  ds_write_b128 v8, v[224:227] offset:16384
  ds_write_b128 v8, v[228:231] offset:17408
  ds_write_b128 v8, v[232:235] offset:24576
  ds_write_b128 v8, v[236:239] offset:25600
  s_waitcnt lgkmcnt(0)
  s_barrier
  ds_read_b128 v[32:35], v9 offset:0
  ds_read_b128 v[36:39], v9 offset:1024
  ds_read_b128 v[40:43], v9 offset:2048
  ds_read_b128 v[44:47], v9 offset:3072
  ds_read_b128 v[48:51], v9 offset:4096
  ds_read_b128 v[52:55], v9 offset:5120
  ds_read_b128 v[56:59], v9 offset:6144
  ds_read_b128 v[60:63], v9 offset:7168
  s_waitcnt lgkmcnt(4)
  v_add_f32 v16, v32, v40
  v_add_f32 v17, v33, v41
  v_add_f32 v18, v34, v42
  v_add_f32 v19, v35, v43
  v_add_f32 v20, v36, v44
  v_add_f32 v21, v37, v45
  v_add_f32 v22, v38, v46
  v_add_f32 v23, v39, v47
  s_waitcnt lgkmcnt(0)
  v_add_f32 v48, v48, v56
  v_add_f32 v49, v49, v57
  v_add_f32 v50, v50, v58
  v_add_f32 v51, v51, v59
  v_add_f32 v52, v52, v60
  v_add_f32 v53, v53, v61
  v_add_f32 v54, v54, v62
  v_add_f32 v55, v55, v63
  v_add_f32 v16, v16, v48
  v_add_f32 v17, v17, v49
  v_add_f32 v18, v18, v50
  v_add_f32 v19, v19, v51
  v_add_f32 v20, v20, v52
  v_add_f32 v21, v21, v53
  v_add_f32 v22, v22, v54
  v_add_f32 v23, v23, v55
  v_lshlrev_b32 v32, 16, v12
  v_and_b32 v33, 0xffff0000, v12
  v_lshlrev_b32 v34, 16, v13
  v_and_b32 v35, 0xffff0000, v13
  v_lshlrev_b32 v36, 16, v14
  v_and_b32 v37, 0xffff0000, v14
  v_lshlrev_b32 v38, 16, v15
  v_and_b32 v39, 0xffff0000, v15
  s_mov_b32 s8, s54
  s_mov_b32 s9, s55
  s_mov_b32 s10, 0x200000
  s_mov_b32 s11, 0x20000
  s_waitcnt vmcnt(0)
  v_fma_f32 v16, v16, v240, v32
  v_fma_f32 v17, v17, v241, v33
  v_fma_f32 v18, v18, v242, v34
  v_fma_f32 v19, v19, v243, v35
  v_fma_f32 v20, v20, v244, v36
  v_fma_f32 v21, v21, v245, v37
  v_fma_f32 v22, v22, v246, v38
  v_fma_f32 v23, v23, v247, v39
  v_cvt_pk_bf16_f32 v32, v16, v17
  v_cvt_pk_bf16_f32 v33, v18, v19
  v_cvt_pk_bf16_f32 v34, v20, v21
  v_cvt_pk_bf16_f32 v35, v22, v23
  v_lshl_add_u32 v6, v3, 3, v6
  s_nop 0
  v_permlane32_swap_b32 v32, v34
  v_permlane32_swap_b32 v33, v35
  buffer_store_dwordx4 v[32:35], v6, s[8:11], s28 offen
  s_endpgm
adaLN_cond__grouped_kv_mqa__glu_gated_swiglu__prompt_kernel_end:
  s_endpgm
.section .rodata,"a"
.p2align 6
.amdhsa_kernel adaLN_cond__grouped_kv_mqa__glu_gated_swiglu__prompt_kernel
  .amdhsa_next_free_vgpr 256
  .amdhsa_next_free_sgpr 102
  .amdhsa_accum_offset 256
  .amdhsa_group_segment_fixed_size 0
  .amdhsa_kernarg_size 112
  .amdhsa_user_sgpr_count 2
  .amdhsa_user_sgpr_kernarg_segment_ptr 1
  .amdhsa_system_sgpr_workgroup_id_x 1
.end_amdhsa_kernel
```
